```python
import torch

def _softmax(x, axis=-1):
    return torch.softmax(x, dim=axis)
def _gelu(x):
    return torch.nn.functional.gelu(x, approximate="tanh")
def _silu(x):
    return torch.nn.functional.silu(x)
def _sigmoid(x):
    return torch.sigmoid(x)
def _layernorm(x, axis=-1, eps=1e-5):
    m = x.mean(dim=axis, keepdim=True)
    v = x.var(dim=axis, keepdim=True, unbiased=False)
    return (x - m) / torch.sqrt(v + eps)
def _scatter_add(tgt, idx, src, axis=0):
    return tgt.clone().index_add_(axis, idx, src)
def _segment_sum(src, seg, n):
    out = torch.zeros((n,) + src.shape[1:], dtype=src.dtype)
    return out.index_add_(0, seg, src)
def _pad(x, pw):
    flat = tuple(v for pair in reversed(pw) for v in pair)
    return torch.nn.functional.pad(x, flat)

kernel_name = 'standalone__gqa_softmax__near_ridge'

def setup_inputs():

    _w = (lambda a: (lambda t: t.to(torch.bfloat16) if t.is_floating_point() else t)(torch.as_tensor(a)))
    B, Hq, Hkv, Sq, Sk, D = 32, 16, 8, 256, 256, 256
    return {
        "q": _w((lambda *s: torch.randn(*s, dtype=torch.bfloat16) * 0.8)(B, Hq, Sq, D)),
        "k": _w((lambda *s: torch.randn(*s, dtype=torch.bfloat16) * 0.8)(B, Hkv, Sk, D)),
        "v": _w((lambda *s: torch.randn(*s, dtype=torch.bfloat16) * 0.05)(B, Hkv, Sk, D)),
    }

def reference(q, k, v):
    B, Hq, Sq, D = q.shape
    Hkv = k.shape[1]
    rep = Hq // Hkv
    k = (lambda x, n, axis: torch.repeat_interleave(x, n, dim=axis))(k, rep, axis=1)
    v = (lambda x, n, axis: torch.repeat_interleave(x, n, dim=axis))(v, rep, axis=1)
    scale = D ** -0.5
    scores = torch.einsum("bhqd,bhkd->bhqk", q, k) * scale
    p = _softmax(scores, axis=-1)
    return torch.einsum("bhqk,bhkd->bhqd", p, v)
```

```asm
; @launch grid=(256,1,1) block=(512,1,1) lds=163328
.amdgcn_target "amdgcn-amd-amdhsa--gfx950"
.text
.globl standalone__gqa_softmax__near_ridge_kernel
.p2align 8
.type standalone__gqa_softmax__near_ridge_kernel,@function
standalone__gqa_softmax__near_ridge_kernel:
    s_cmp_ge_u32 s2, 256
    s_cbranch_scc1 L_end
    s_load_dwordx4 s[4:7], s[0:1], 0
    s_load_dwordx4 s[8:11], s[0:1], 16
    v_lshrrev_b32 v1, 6, v0
    v_and_b32 v2, 63, v0
    v_readfirstlane_b32 s32, v1
    v_and_b32 v64, 31, v2
    v_lshrrev_b32 v65, 5, v2
    s_and_b32 s3, s32, 3
    s_mul_i32 s39, s3, 40832
    s_lshl_b32 s14, s2, 18
    s_lshl_b32 s15, s2, 17
    v_xor_b32 v11, v64, v65
    v_lshlrev_b32 v11, 4, v11
    v_lshl_add_u32 v11, v65, 9, v11
    s_lshl_b32 s40, s3, 12
    v_add_u32 v11, s40, v11
    v_lshrrev_b32 v66, 3, v2
    v_and_b32 v67, 7, v2
    v_lshlrev_b32 v12, 9, v66
    v_lshl_add_u32 v12, v67, 4, v12
    s_waitcnt lgkmcnt(0)
    s_add_u32 s16, s4, s14
    s_addc_u32 s17, s5, 0
    s_mov_b32 s18, 262144
    s_mov_b32 s19, 0x20000
    s_add_u32 s20, s6, s15
    s_addc_u32 s21, s7, 0
    s_mov_b32 s22, 131072
    s_mov_b32 s23, 0x20000
    s_add_u32 s24, s8, s15
    s_addc_u32 s25, s9, 0
    s_mov_b32 s26, 131072
    s_mov_b32 s27, 0x20000
    s_add_u32 s28, s10, s14
    s_addc_u32 s29, s11, 0
    s_mov_b32 s30, 262144
    s_mov_b32 s31, 0x20000
    s_cmp_ge_u32 s32, 4
    s_cbranch_scc1 L_pv
    s_mov_b32 s54, 0
    s_add_u32 m0, s39, 0
    s_nop 0
    buffer_load_dwordx4 v11, s[16:19], s54 offen offset:0 nt lds
    s_add_u32 m0, s39, 32
    s_nop 0
    buffer_load_dwordx4 v11, s[16:19], s54 offen offset:1024 nt lds
    s_add_u32 m0, s39, 64
    s_nop 0
    buffer_load_dwordx4 v11, s[16:19], s54 offen offset:2048 nt lds
    s_add_u32 m0, s39, 96
    s_nop 0
    buffer_load_dwordx4 v11, s[16:19], s54 offen offset:3072 nt lds
    s_lshl_b32 s44, s3, 15
    v_and_b32 v68, 15, v2
    v_lshrrev_b32 v69, 4, v2
    v_xor_b32 v70, v67, v66
    v_lshlrev_b32 v70, 4, v70
    v_lshl_add_u32 v70, v66, 7, v70
    s_add_u32 s40, s39, 25344
    v_add_u32 v17, s40, v70
    v_lshrrev_b32 v71, 2, v68
    v_and_b32 v72, 3, v68
    v_lshl_add_u32 v71, v71, 3, v72
    v_lshlrev_b32 v71, 7, v71
    v_xor_b32 v72, v72, v69
    v_lshl_add_u32 v71, v72, 4, v71
    v_add_u32 v18, s40, v71
    buffer_load_dwordx4 v[128:131], v12, s[20:23], s44 offen offset:0 nt
    buffer_load_dwordx4 v[144:147], v12, s[20:23], s44 offen offset:128 nt
    buffer_load_dwordx4 v[160:163], v12, s[20:23], s44 offen offset:256 nt
    buffer_load_dwordx4 v[176:179], v12, s[20:23], s44 offen offset:384 nt
    s_add_u32 s44, s44, 4096
    buffer_load_dwordx4 v[132:135], v12, s[20:23], s44 offen offset:0 nt
    buffer_load_dwordx4 v[148:151], v12, s[20:23], s44 offen offset:128 nt
    buffer_load_dwordx4 v[164:167], v12, s[20:23], s44 offen offset:256 nt
    buffer_load_dwordx4 v[180:183], v12, s[20:23], s44 offen offset:384 nt
    s_add_u32 s44, s44, 4096
    buffer_load_dwordx4 v[136:139], v12, s[20:23], s44 offen offset:0 nt
    buffer_load_dwordx4 v[152:155], v12, s[20:23], s44 offen offset:128 nt
    buffer_load_dwordx4 v[168:171], v12, s[20:23], s44 offen offset:256 nt
    buffer_load_dwordx4 v[184:187], v12, s[20:23], s44 offen offset:384 nt
    s_add_u32 s44, s44, 4096
    buffer_load_dwordx4 v[140:143], v12, s[20:23], s44 offen offset:0 nt
    buffer_load_dwordx4 v[156:159], v12, s[20:23], s44 offen offset:128 nt
    buffer_load_dwordx4 v[172:175], v12, s[20:23], s44 offen offset:256 nt
    buffer_load_dwordx4 v[188:191], v12, s[20:23], s44 offen offset:384 nt
    s_add_u32 s44, s44, 4096
    buffer_load_dwordx4 v[192:195], v12, s[20:23], s44 offen offset:0 nt
    buffer_load_dwordx4 v[208:211], v12, s[20:23], s44 offen offset:128 nt
    buffer_load_dwordx4 v[224:227], v12, s[20:23], s44 offen offset:256 nt
    buffer_load_dwordx4 v[240:243], v12, s[20:23], s44 offen offset:384 nt
    s_add_u32 s44, s44, 4096
    buffer_load_dwordx4 v[196:199], v12, s[20:23], s44 offen offset:0 nt
    buffer_load_dwordx4 v[212:215], v12, s[20:23], s44 offen offset:128 nt
    buffer_load_dwordx4 v[228:231], v12, s[20:23], s44 offen offset:256 nt
    buffer_load_dwordx4 v[244:247], v12, s[20:23], s44 offen offset:384 nt
    s_add_u32 s44, s44, 4096
    buffer_load_dwordx4 v[200:203], v12, s[20:23], s44 offen offset:0 nt
    buffer_load_dwordx4 v[216:219], v12, s[20:23], s44 offen offset:128 nt
    buffer_load_dwordx4 v[232:235], v12, s[20:23], s44 offen offset:256 nt
    buffer_load_dwordx4 v[248:251], v12, s[20:23], s44 offen offset:384 nt
    s_add_u32 s44, s44, 4096
    s_waitcnt vmcnt(15)
    ds_write_b128 v17, v[128:131] offset:0
    ds_write_b128 v17, v[132:135] offset:1024
    ds_write_b128 v17, v[136:139] offset:2048
    ds_write_b128 v17, v[140:143] offset:3072
    s_waitcnt lgkmcnt(0)
    ds_read_b128 v[128:131], v18 offset:0
    ds_read_b128 v[132:135], v18 offset:576
    ds_read_b128 v[136:139], v18 offset:64
    ds_read_b128 v[140:143], v18 offset:512
    s_waitcnt vmcnt(14)
    ds_write_b128 v17, v[144:147] offset:0
    ds_write_b128 v17, v[148:151] offset:1024
    ds_write_b128 v17, v[152:155] offset:2048
    ds_write_b128 v17, v[156:159] offset:3072
    s_waitcnt lgkmcnt(0)
    ds_read_b128 v[144:147], v18 offset:0
    ds_read_b128 v[148:151], v18 offset:576
    ds_read_b128 v[152:155], v18 offset:64
    ds_read_b128 v[156:159], v18 offset:512
    buffer_load_dwordx4 v[204:207], v12, s[20:23], s44 offen offset:0 nt
    buffer_load_dwordx4 v[220:223], v12, s[20:23], s44 offen offset:128 nt
    buffer_load_dwordx4 v[236:239], v12, s[20:23], s44 offen offset:256 nt
    buffer_load_dwordx4 v[252:255], v12, s[20:23], s44 offen offset:384 nt
    s_add_u32 s44, s44, 4096
    s_waitcnt vmcnt(17)
    ds_write_b128 v17, v[160:163] offset:0
    ds_write_b128 v17, v[164:167] offset:1024
    ds_write_b128 v17, v[168:171] offset:2048
    ds_write_b128 v17, v[172:175] offset:3072
    s_waitcnt lgkmcnt(0)
    ds_read_b128 v[160:163], v18 offset:0
    ds_read_b128 v[164:167], v18 offset:576
    ds_read_b128 v[168:171], v18 offset:64
    ds_read_b128 v[172:175], v18 offset:512
    s_waitcnt vmcnt(16)
    ds_write_b128 v17, v[176:179] offset:0
    ds_write_b128 v17, v[180:183] offset:1024
    ds_write_b128 v17, v[184:187] offset:2048
    ds_write_b128 v17, v[188:191] offset:3072
    s_waitcnt lgkmcnt(0)
    ds_read_b128 v[176:179], v18 offset:0
    ds_read_b128 v[180:183], v18 offset:576
    ds_read_b128 v[184:187], v18 offset:64
    ds_read_b128 v[188:191], v18 offset:512
    s_barrier
    s_mov_b32 s54, 16384
    s_add_u32 m0, s39, 4224
    s_nop 0
    buffer_load_dwordx4 v11, s[16:19], s54 offen offset:0 nt lds
    s_add_u32 m0, s39, 4256
    s_nop 0
    buffer_load_dwordx4 v11, s[16:19], s54 offen offset:1024 nt lds
    s_add_u32 m0, s39, 4288
    s_nop 0
    buffer_load_dwordx4 v11, s[16:19], s54 offen offset:2048 nt lds
    s_add_u32 m0, s39, 4320
    s_nop 0
    buffer_load_dwordx4 v11, s[16:19], s54 offen offset:3072 nt lds
    v_lshrrev_b32 v71, 3, v68
    v_mul_u32_u24 v13, 40832, v71
    v_bfe_u32 v71, v68, 1, 2
    v_mul_u32_u24 v71, 1056, v71
    v_add_u32 v13, v13, v71
    v_and_b32 v71, 1, v68
    v_lshl_add_u32 v13, v71, 9, v13
    v_xor_b32 v71, v71, v69
    v_lshl_add_u32 v13, v71, 4, v13
    v_add_u32 v14, 81664, v13
    s_lshl_b32 s40, s3, 7
    s_add_u32 s40, s40, 25344
    v_add_u32 v25, s40, v13
    v_mov_b32 v15, v13
    v_add_u32 v26, s40, v14
    v_mov_b32 v24, v14
    v_lshl_add_u32 v72, v65, 4, v68
    v_lshrrev_b32 v71, 3, v72
    v_mul_u32_u24 v27, 40832, v71
    v_and_b32 v71, 7, v72
    v_lshl_add_u32 v27, v71, 5, v27
    v_add_u32 v27, 37888, v27
    v_and_b32 v71, 1, v69
    s_lshl_b32 s40, s3, 3
    v_lshl_add_u32 v28, v71, 2, v27
    v_add_u32 v28, s40, v28
    s_mov_b32 s38, 0x3db8aa3b
    s_mov_b32 s34, 0
    s_waitcnt vmcnt(7)
    ds_write_b128 v17, v[192:195] offset:0
    ds_write_b128 v17, v[196:199] offset:1024
    ds_write_b128 v17, v[200:203] offset:2048
    ds_write_b128 v17, v[204:207] offset:3072
    s_waitcnt lgkmcnt(0)
    ds_read_b128 v[192:195], v18 offset:0
    ds_read_b128 v[196:199], v18 offset:576
    ds_read_b128 v[200:203], v18 offset:64
    ds_read_b128 v[204:207], v18 offset:512
    s_waitcnt vmcnt(6)
    ds_write_b128 v17, v[208:211] offset:0
    ds_write_b128 v17, v[212:215] offset:1024
    ds_write_b128 v17, v[216:219] offset:2048
    ds_write_b128 v17, v[220:223] offset:3072
    s_waitcnt lgkmcnt(0)
    ds_read_b128 v[208:211], v18 offset:0
    ds_read_b128 v[212:215], v18 offset:576
    ds_read_b128 v[216:219], v18 offset:64
    ds_read_b128 v[220:223], v18 offset:512
    s_waitcnt vmcnt(5)
    ds_write_b128 v17, v[224:227] offset:0
    ds_write_b128 v17, v[228:231] offset:1024
    ds_write_b128 v17, v[232:235] offset:2048
    ds_write_b128 v17, v[236:239] offset:3072
    s_waitcnt lgkmcnt(0)
    ds_read_b128 v[224:227], v18 offset:0
    ds_read_b128 v[228:231], v18 offset:576
    ds_read_b128 v[232:235], v18 offset:64
    ds_read_b128 v[236:239], v18 offset:512
    s_waitcnt vmcnt(4)
    ds_write_b128 v17, v[240:243] offset:0
    ds_write_b128 v17, v[244:247] offset:1024
    ds_write_b128 v17, v[248:251] offset:2048
    ds_write_b128 v17, v[252:255] offset:3072
    s_waitcnt lgkmcnt(0)
    ds_read_b128 v[240:243], v18 offset:0
    ds_read_b128 v[244:247], v18 offset:576
    ds_read_b128 v[248:251], v18 offset:64
    ds_read_b128 v[252:255], v18 offset:512
    s_waitcnt lgkmcnt(0)
    s_barrier
    s_mov_b32 s33, -1
    s_branch L_s_loop1
L_s_loop0:
    ds_read_b128 v[16:19], v27 offset:0
    ds_read_b128 v[20:23], v27 offset:16
    s_cmp_gt_i32 s33, 3
    s_cbranch_scc1 L_s_pre0
    ds_read_b128 v[32:35], v15 offset:0
    ds_read_b128 v[36:39], v24 offset:0
    ds_read_b128 v[40:43], v15 offset:64
    ds_read_b128 v[44:47], v24 offset:64
    ds_read_b128 v[48:51], v15 offset:128
    ds_read_b128 v[52:55], v24 offset:128
    s_waitcnt lgkmcnt(0)
L_s_pre0:
    v_mfma_f32_16x16x32_bf16 v[64:67], v[128:131], v[32:35], 0
    v_mfma_f32_16x16x32_bf16 v[68:71], v[132:135], v[32:35], 0
    v_mfma_f32_16x16x32_bf16 v[72:75], v[192:195], v[32:35], 0
    v_mfma_f32_16x16x32_bf16 v[76:79], v[196:199], v[32:35], 0
    v_mfma_f32_16x16x32_bf16 v[80:83], v[128:131], v[36:39], 0
    v_mfma_f32_16x16x32_bf16 v[84:87], v[132:135], v[36:39], 0
    v_mfma_f32_16x16x32_bf16 v[88:91], v[192:195], v[36:39], 0
    s_waitcnt lgkmcnt(0)
    v_max3_f32 v29, v16, v17, v18
    v_max3_f32 v19, v19, v20, v21
    v_max3_f32 v29, v29, v22, v23
    v_mfma_f32_16x16x32_bf16 v[92:95], v[196:199], v[36:39], 0
    ds_read_b128 v[56:59], v15 offset:192
    ds_read_b128 v[60:63], v24 offset:192
    v_max_f32 v29, v29, v19
    v_mul_f32 v29, s38, v29
    v_mfma_f32_16x16x32_bf16 v[64:67], v[136:139], v[40:43], v[64:67]
    v_mov_b32 v3, v29
    s_nop 1
    v_permlane32_swap_b32 v29, v3
    v_mfma_f32_16x16x32_bf16 v[68:71], v[140:143], v[40:43], v[68:71]
    v_fma_f32 v96, v96, s38, -v29
    v_fma_f32 v97, v97, s38, -v29
    v_fma_f32 v98, v98, s38, -v29
    v_mfma_f32_16x16x32_bf16 v[72:75], v[200:203], v[40:43], v[72:75]
    v_exp_f32 v96, v96
    v_fma_f32 v99, v99, s38, -v29
    v_mfma_f32_16x16x32_bf16 v[76:79], v[204:207], v[40:43], v[76:79]
    v_exp_f32 v97, v97
    v_fma_f32 v100, v100, s38, -v29
    v_mfma_f32_16x16x32_bf16 v[80:83], v[136:139], v[44:47], v[80:83]
    v_exp_f32 v98, v98
    v_mfma_f32_16x16x32_bf16 v[84:87], v[140:143], v[44:47], v[84:87]
    v_mov_b32 v4, v96
    v_fma_f32 v101, v101, s38, -v29
    v_exp_f32 v99, v99
    v_mfma_f32_16x16x32_bf16 v[88:91], v[200:203], v[44:47], v[88:91]
    v_add_f32 v4, v4, v97
    v_fma_f32 v102, v102, s38, -v29
    v_mfma_f32_16x16x32_bf16 v[92:95], v[204:207], v[44:47], v[92:95]
    ds_read_b128 v[32:35], v15 offset:256
    ds_read_b128 v[36:39], v24 offset:256
    v_exp_f32 v100, v100
    v_add_f32 v4, v4, v98
    v_mfma_f32_16x16x32_bf16 v[64:67], v[144:147], v[48:51], v[64:67]
    v_cvt_pk_bf16_f32 v96, v96, v97
    v_fma_f32 v103, v103, s38, -v29
    v_mfma_f32_16x16x32_bf16 v[68:71], v[148:151], v[48:51], v[68:71]
    v_exp_f32 v101, v101
    v_add_f32 v4, v4, v99
    v_mfma_f32_16x16x32_bf16 v[72:75], v[208:211], v[48:51], v[72:75]
    v_fma_f32 v104, v104, s38, -v29
    v_exp_f32 v102, v102
    v_mfma_f32_16x16x32_bf16 v[76:79], v[212:215], v[48:51], v[76:79]
    v_add_f32 v4, v4, v100
    v_cvt_pk_bf16_f32 v97, v98, v99
    v_fma_f32 v105, v105, s38, -v29
    v_mfma_f32_16x16x32_bf16 v[80:83], v[144:147], v[52:55], v[80:83]
    v_exp_f32 v103, v103
    v_mfma_f32_16x16x32_bf16 v[84:87], v[148:151], v[52:55], v[84:87]
    v_add_f32 v4, v4, v101
    v_fma_f32 v106, v106, s38, -v29
    v_exp_f32 v104, v104
    v_mfma_f32_16x16x32_bf16 v[88:91], v[208:211], v[52:55], v[88:91]
    v_add_f32 v4, v4, v102
    v_cvt_pk_bf16_f32 v98, v100, v101
    v_mfma_f32_16x16x32_bf16 v[92:95], v[212:215], v[52:55], v[92:95]
    ds_read_b128 v[40:43], v15 offset:320
    ds_read_b128 v[44:47], v24 offset:320
    v_fma_f32 v107, v107, s38, -v29
    v_exp_f32 v105, v105
    s_waitcnt lgkmcnt(4)
    v_mfma_f32_16x16x32_bf16 v[64:67], v[152:155], v[56:59], v[64:67]
    v_add_f32 v4, v4, v103
    v_fma_f32 v108, v108, s38, -v29
    v_mfma_f32_16x16x32_bf16 v[68:71], v[156:159], v[56:59], v[68:71]
    v_exp_f32 v106, v106
    v_add_f32 v4, v4, v104
    v_mfma_f32_16x16x32_bf16 v[72:75], v[216:219], v[56:59], v[72:75]
    v_cvt_pk_bf16_f32 v99, v102, v103
    ds_write_b128 v25, v[96:99] offset:0
    v_fma_f32 v109, v109, s38, -v29
    v_mfma_f32_16x16x32_bf16 v[76:79], v[220:223], v[56:59], v[76:79]
    v_exp_f32 v107, v107
    v_add_f32 v4, v4, v105
    v_mfma_f32_16x16x32_bf16 v[80:83], v[152:155], v[60:63], v[80:83]
    v_fma_f32 v110, v110, s38, -v29
    v_exp_f32 v108, v108
    v_mfma_f32_16x16x32_bf16 v[84:87], v[156:159], v[60:63], v[84:87]
    v_add_f32 v4, v4, v106
    v_cvt_pk_bf16_f32 v104, v104, v105
    v_mfma_f32_16x16x32_bf16 v[88:91], v[216:219], v[60:63], v[88:91]
    v_fma_f32 v111, v111, s38, -v29
    v_exp_f32 v109, v109
    v_mfma_f32_16x16x32_bf16 v[92:95], v[220:223], v[60:63], v[92:95]
    ds_read_b128 v[48:51], v15 offset:384
    ds_read_b128 v[52:55], v24 offset:384
    v_add_f32 v4, v4, v107
    v_fma_f32 v112, v112, s38, -v3
    s_waitcnt lgkmcnt(5)
    v_mfma_f32_16x16x32_bf16 v[64:67], v[160:163], v[32:35], v[64:67]
    v_exp_f32 v110, v110
    v_add_f32 v4, v4, v108
    v_mfma_f32_16x16x32_bf16 v[68:71], v[164:167], v[32:35], v[68:71]
    v_cvt_pk_bf16_f32 v105, v106, v107
    v_fma_f32 v113, v113, s38, -v3
    v_exp_f32 v111, v111
    v_mfma_f32_16x16x32_bf16 v[72:75], v[224:227], v[32:35], v[72:75]
    v_add_f32 v4, v4, v109
    v_fma_f32 v114, v114, s38, -v3
    v_mfma_f32_16x16x32_bf16 v[76:79], v[228:231], v[32:35], v[76:79]
    v_exp_f32 v112, v112
    v_add_f32 v4, v4, v110
    v_mfma_f32_16x16x32_bf16 v[80:83], v[160:163], v[36:39], v[80:83]
    v_cvt_pk_bf16_f32 v106, v108, v109
    v_fma_f32 v115, v115, s38, -v3
    v_mfma_f32_16x16x32_bf16 v[84:87], v[164:167], v[36:39], v[84:87]
    v_exp_f32 v113, v113
    v_add_f32 v4, v4, v111
    v_mfma_f32_16x16x32_bf16 v[88:91], v[224:227], v[36:39], v[88:91]
    v_fma_f32 v116, v116, s38, -v3
    v_exp_f32 v114, v114
    v_mfma_f32_16x16x32_bf16 v[92:95], v[228:231], v[36:39], v[92:95]
    ds_read_b128 v[56:59], v15 offset:448
    ds_read_b128 v[60:63], v24 offset:448
    v_mov_b32 v5, v112
    v_cvt_pk_bf16_f32 v107, v110, v111
    ds_write_b128 v25, v[104:107] offset:64
    s_waitcnt lgkmcnt(6)
    v_mfma_f32_16x16x32_bf16 v[64:67], v[168:171], v[40:43], v[64:67]
    v_fma_f32 v117, v117, s38, -v3
    v_exp_f32 v115, v115
    v_mfma_f32_16x16x32_bf16 v[68:71], v[172:175], v[40:43], v[68:71]
    v_add_f32 v5, v5, v113
    v_fma_f32 v118, v118, s38, -v3
    v_mfma_f32_16x16x32_bf16 v[72:75], v[232:235], v[40:43], v[72:75]
    v_exp_f32 v116, v116
    v_add_f32 v5, v5, v114
    v_mfma_f32_16x16x32_bf16 v[76:79], v[236:239], v[40:43], v[76:79]
    v_cvt_pk_bf16_f32 v112, v112, v113
    v_fma_f32 v119, v119, s38, -v3
    v_mfma_f32_16x16x32_bf16 v[80:83], v[168:171], v[44:47], v[80:83]
    v_exp_f32 v117, v117
    v_add_f32 v5, v5, v115
    v_fma_f32 v120, v120, s38, -v3
    v_mfma_f32_16x16x32_bf16 v[84:87], v[172:175], v[44:47], v[84:87]
    v_exp_f32 v118, v118
    v_mfma_f32_16x16x32_bf16 v[88:91], v[232:235], v[44:47], v[88:91]
    v_add_f32 v5, v5, v116
    v_cvt_pk_bf16_f32 v113, v114, v115
    v_fma_f32 v121, v121, s38, -v3
    v_mfma_f32_16x16x32_bf16 v[92:95], v[236:239], v[44:47], v[92:95]
    s_add_u32 s34, s34, 4224
    s_cmp_eq_u32 s34, 25344
    s_cselect_b32 s34, 0, s34
    v_add_u32 v15, s34, v13
    v_add_u32 v24, s34, v14
    ds_read_b128 v[32:35], v15 offset:0
    ds_read_b128 v[36:39], v24 offset:0
    v_exp_f32 v119, v119
    v_add_f32 v5, v5, v117
    s_waitcnt lgkmcnt(5)
    v_mfma_f32_16x16x32_bf16 v[64:67], v[176:179], v[48:51], v[64:67]
    v_fma_f32 v122, v122, s38, -v3
    v_exp_f32 v120, v120
    v_mfma_f32_16x16x32_bf16 v[68:71], v[180:183], v[48:51], v[68:71]
    v_add_f32 v5, v5, v118
    v_cvt_pk_bf16_f32 v114, v116, v117
    v_mfma_f32_16x16x32_bf16 v[72:75], v[240:243], v[48:51], v[72:75]
    v_fma_f32 v123, v123, s38, -v3
    v_exp_f32 v121, v121
    v_mfma_f32_16x16x32_bf16 v[76:79], v[244:247], v[48:51], v[76:79]
    v_add_f32 v5, v5, v119
    v_fma_f32 v124, v124, s38, -v3
    v_mfma_f32_16x16x32_bf16 v[80:83], v[176:179], v[52:55], v[80:83]
    v_exp_f32 v122, v122
    v_add_f32 v5, v5, v120
    v_cvt_pk_bf16_f32 v115, v118, v119
    v_mfma_f32_16x16x32_bf16 v[84:87], v[180:183], v[52:55], v[84:87]
    ds_write_b128 v26, v[112:115] offset:0
    v_fma_f32 v125, v125, s38, -v3
    v_mfma_f32_16x16x32_bf16 v[88:91], v[240:243], v[52:55], v[88:91]
    v_exp_f32 v123, v123
    v_add_f32 v5, v5, v121
    v_mfma_f32_16x16x32_bf16 v[92:95], v[244:247], v[52:55], v[92:95]
    ds_read_b128 v[40:43], v15 offset:64
    ds_read_b128 v[44:47], v24 offset:64
    v_fma_f32 v126, v126, s38, -v3
    v_exp_f32 v124, v124
    s_waitcnt lgkmcnt(6)
    v_mfma_f32_16x16x32_bf16 v[64:67], v[184:187], v[56:59], v[64:67]
    v_add_f32 v5, v5, v122
    v_cvt_pk_bf16_f32 v120, v120, v121
    v_fma_f32 v127, v127, s38, -v3
    v_mfma_f32_16x16x32_bf16 v[68:71], v[188:191], v[56:59], v[68:71]
    v_exp_f32 v125, v125
    v_mfma_f32_16x16x32_bf16 v[72:75], v[248:251], v[56:59], v[72:75]
    v_add_f32 v5, v5, v123
    v_exp_f32 v126, v126
    v_mfma_f32_16x16x32_bf16 v[76:79], v[252:255], v[56:59], v[76:79]
    v_add_f32 v5, v5, v124
    v_cvt_pk_bf16_f32 v121, v122, v123
    v_mfma_f32_16x16x32_bf16 v[80:83], v[184:187], v[60:63], v[80:83]
    v_exp_f32 v127, v127
    v_add_f32 v5, v5, v125
    v_add_f32 v5, v5, v126
    v_mfma_f32_16x16x32_bf16 v[84:87], v[188:191], v[60:63], v[84:87]
    v_cvt_pk_bf16_f32 v122, v124, v125
    v_add_f32 v5, v5, v127
    v_mfma_f32_16x16x32_bf16 v[88:91], v[248:251], v[60:63], v[88:91]
    v_cvt_pk_bf16_f32 v123, v126, v127
    ds_write_b128 v26, v[120:123] offset:64
    s_nop 0
    v_permlane32_swap_b32 v4, v5
    v_mfma_f32_16x16x32_bf16 v[92:95], v[252:255], v[60:63], v[92:95]
    ds_read_b128 v[48:51], v15 offset:128
    ds_read_b128 v[52:55], v24 offset:128
    v_add_f32 v4, v4, v5
    ds_write_b32 v28, v4 offset:512
    s_nop 6
    v_max3_f32 v6, v64, v65, v66
    v_max3_f32 v6, v6, v67, v68
    v_max3_f32 v6, v6, v69, v70
    v_max3_f32 v6, v6, v71, v72
    v_max3_f32 v6, v6, v73, v74
    v_max3_f32 v6, v6, v75, v76
    v_max3_f32 v6, v6, v77, v78
    v_max_f32 v6, v6, v79
    v_max3_f32 v7, v80, v81, v82
    v_max3_f32 v7, v7, v83, v84
    v_max3_f32 v7, v7, v85, v86
    v_max3_f32 v7, v7, v87, v88
    v_max3_f32 v7, v7, v89, v90
    v_max3_f32 v7, v7, v91, v92
    v_max3_f32 v7, v7, v93, v94
    v_max_f32 v7, v7, v95
    s_nop 1
    v_permlane32_swap_b32 v6, v7
    v_max_f32 v6, v6, v7
    ds_write_b32 v28, v6 offset:256
    s_waitcnt vmcnt(0) lgkmcnt(0)
    s_cmp_lg_u32 s33, 0
    s_cbranch_scc1 L_s_noq3
    s_mov_b32 s54, 49152
    s_add_u32 m0, s39, 12672
    s_nop 0
    buffer_load_dwordx4 v11, s[16:19], s54 offen offset:0 nt lds
    s_add_u32 m0, s39, 12704
    s_nop 0
    buffer_load_dwordx4 v11, s[16:19], s54 offen offset:1024 nt lds
    s_add_u32 m0, s39, 12736
    s_nop 0
    buffer_load_dwordx4 v11, s[16:19], s54 offen offset:2048 nt lds
    s_add_u32 m0, s39, 12768
    s_nop 0
    buffer_load_dwordx4 v11, s[16:19], s54 offen offset:3072 nt lds
L_s_noq3:
    s_barrier
    s_add_u32 s33, s33, 1
L_s_loop1:
    ds_read_b128 v[16:19], v27 offset:256
    ds_read_b128 v[20:23], v27 offset:272
    s_cmp_eq_u32 s33, 15
    s_cbranch_scc1 L_s_last
    s_cmp_lg_u32 s33, -1
    s_cbranch_scc1 L_s_noq2
    s_mov_b32 s54, 32768
    s_add_u32 m0, s39, 8448
    s_nop 0
    buffer_load_dwordx4 v11, s[16:19], s54 offen offset:0 nt lds
    s_add_u32 m0, s39, 8480
    s_nop 0
    buffer_load_dwordx4 v11, s[16:19], s54 offen offset:1024 nt lds
    s_add_u32 m0, s39, 8512
    s_nop 0
    buffer_load_dwordx4 v11, s[16:19], s54 offen offset:2048 nt lds
    s_add_u32 m0, s39, 8544
    s_nop 0
    buffer_load_dwordx4 v11, s[16:19], s54 offen offset:3072 nt lds
L_s_noq2:
    s_cmp_gt_i32 s33, 3
    s_cbranch_scc1 L_s_pre1
    ds_read_b128 v[32:35], v15 offset:0
    ds_read_b128 v[36:39], v24 offset:0
    ds_read_b128 v[40:43], v15 offset:64
    ds_read_b128 v[44:47], v24 offset:64
    ds_read_b128 v[48:51], v15 offset:128
    ds_read_b128 v[52:55], v24 offset:128
    s_waitcnt lgkmcnt(0)
L_s_pre1:
    v_mfma_f32_16x16x32_bf16 v[96:99], v[128:131], v[32:35], 0
    v_mfma_f32_16x16x32_bf16 v[100:103], v[132:135], v[32:35], 0
    v_mfma_f32_16x16x32_bf16 v[104:107], v[192:195], v[32:35], 0
    v_mfma_f32_16x16x32_bf16 v[108:111], v[196:199], v[32:35], 0
    v_mfma_f32_16x16x32_bf16 v[112:115], v[128:131], v[36:39], 0
    v_mfma_f32_16x16x32_bf16 v[116:119], v[132:135], v[36:39], 0
    v_mfma_f32_16x16x32_bf16 v[120:123], v[192:195], v[36:39], 0
    s_waitcnt lgkmcnt(0)
    v_max3_f32 v29, v16, v17, v18
    v_max3_f32 v19, v19, v20, v21
    v_max3_f32 v29, v29, v22, v23
    v_mfma_f32_16x16x32_bf16 v[124:127], v[196:199], v[36:39], 0
    ds_read_b128 v[56:59], v15 offset:192
    ds_read_b128 v[60:63], v24 offset:192
    v_max_f32 v29, v29, v19
    v_mul_f32 v29, s38, v29
    v_mfma_f32_16x16x32_bf16 v[96:99], v[136:139], v[40:43], v[96:99]
    v_mov_b32 v3, v29
    s_nop 1
    v_permlane32_swap_b32 v29, v3
    v_mfma_f32_16x16x32_bf16 v[100:103], v[140:143], v[40:43], v[100:103]
    v_fma_f32 v64, v64, s38, -v29
    v_fma_f32 v65, v65, s38, -v29
    v_fma_f32 v66, v66, s38, -v29
    v_mfma_f32_16x16x32_bf16 v[104:107], v[200:203], v[40:43], v[104:107]
    v_exp_f32 v64, v64
    v_fma_f32 v67, v67, s38, -v29
    v_mfma_f32_16x16x32_bf16 v[108:111], v[204:207], v[40:43], v[108:111]
    v_exp_f32 v65, v65
    v_fma_f32 v68, v68, s38, -v29
    v_mfma_f32_16x16x32_bf16 v[112:115], v[136:139], v[44:47], v[112:115]
    v_exp_f32 v66, v66
    v_mfma_f32_16x16x32_bf16 v[116:119], v[140:143], v[44:47], v[116:119]
    v_mov_b32 v4, v64
    v_fma_f32 v69, v69, s38, -v29
    v_exp_f32 v67, v67
    v_mfma_f32_16x16x32_bf16 v[120:123], v[200:203], v[44:47], v[120:123]
    v_add_f32 v4, v4, v65
    v_fma_f32 v70, v70, s38, -v29
    v_mfma_f32_16x16x32_bf16 v[124:127], v[204:207], v[44:47], v[124:127]
    ds_read_b128 v[32:35], v15 offset:256
    ds_read_b128 v[36:39], v24 offset:256
    v_exp_f32 v68, v68
    v_add_f32 v4, v4, v66
    v_mfma_f32_16x16x32_bf16 v[96:99], v[144:147], v[48:51], v[96:99]
    v_cvt_pk_bf16_f32 v64, v64, v65
    v_fma_f32 v71, v71, s38, -v29
    v_mfma_f32_16x16x32_bf16 v[100:103], v[148:151], v[48:51], v[100:103]
    v_exp_f32 v69, v69
    v_add_f32 v4, v4, v67
    v_mfma_f32_16x16x32_bf16 v[104:107], v[208:211], v[48:51], v[104:107]
    v_fma_f32 v72, v72, s38, -v29
    v_exp_f32 v70, v70
    v_mfma_f32_16x16x32_bf16 v[108:111], v[212:215], v[48:51], v[108:111]
    v_add_f32 v4, v4, v68
    v_cvt_pk_bf16_f32 v65, v66, v67
    v_fma_f32 v73, v73, s38, -v29
    v_mfma_f32_16x16x32_bf16 v[112:115], v[144:147], v[52:55], v[112:115]
    v_exp_f32 v71, v71
    v_mfma_f32_16x16x32_bf16 v[116:119], v[148:151], v[52:55], v[116:119]
    v_add_f32 v4, v4, v69
    v_fma_f32 v74, v74, s38, -v29
    v_exp_f32 v72, v72
    v_mfma_f32_16x16x32_bf16 v[120:123], v[208:211], v[52:55], v[120:123]
    v_add_f32 v4, v4, v70
    v_cvt_pk_bf16_f32 v66, v68, v69
    v_mfma_f32_16x16x32_bf16 v[124:127], v[212:215], v[52:55], v[124:127]
    ds_read_b128 v[40:43], v15 offset:320
    ds_read_b128 v[44:47], v24 offset:320
    v_fma_f32 v75, v75, s38, -v29
    v_exp_f32 v73, v73
    s_waitcnt lgkmcnt(4)
    v_mfma_f32_16x16x32_bf16 v[96:99], v[152:155], v[56:59], v[96:99]
    v_add_f32 v4, v4, v71
    v_fma_f32 v76, v76, s38, -v29
    v_mfma_f32_16x16x32_bf16 v[100:103], v[156:159], v[56:59], v[100:103]
    v_exp_f32 v74, v74
    v_add_f32 v4, v4, v72
    v_mfma_f32_16x16x32_bf16 v[104:107], v[216:219], v[56:59], v[104:107]
    v_cvt_pk_bf16_f32 v67, v70, v71
    ds_write_b128 v25, v[64:67] offset:4224
    v_fma_f32 v77, v77, s38, -v29
    v_mfma_f32_16x16x32_bf16 v[108:111], v[220:223], v[56:59], v[108:111]
    v_exp_f32 v75, v75
    v_add_f32 v4, v4, v73
    v_mfma_f32_16x16x32_bf16 v[112:115], v[152:155], v[60:63], v[112:115]
    v_fma_f32 v78, v78, s38, -v29
    v_exp_f32 v76, v76
    v_mfma_f32_16x16x32_bf16 v[116:119], v[156:159], v[60:63], v[116:119]
    v_add_f32 v4, v4, v74
    v_cvt_pk_bf16_f32 v72, v72, v73
    v_mfma_f32_16x16x32_bf16 v[120:123], v[216:219], v[60:63], v[120:123]
    v_fma_f32 v79, v79, s38, -v29
    v_exp_f32 v77, v77
    v_mfma_f32_16x16x32_bf16 v[124:127], v[220:223], v[60:63], v[124:127]
    ds_read_b128 v[48:51], v15 offset:384
    ds_read_b128 v[52:55], v24 offset:384
    v_add_f32 v4, v4, v75
    v_fma_f32 v80, v80, s38, -v3
    s_waitcnt lgkmcnt(5)
    v_mfma_f32_16x16x32_bf16 v[96:99], v[160:163], v[32:35], v[96:99]
    v_exp_f32 v78, v78
    v_add_f32 v4, v4, v76
    v_mfma_f32_16x16x32_bf16 v[100:103], v[164:167], v[32:35], v[100:103]
    v_cvt_pk_bf16_f32 v73, v74, v75
    v_fma_f32 v81, v81, s38, -v3
    v_exp_f32 v79, v79
    v_mfma_f32_16x16x32_bf16 v[104:107], v[224:227], v[32:35], v[104:107]
    v_add_f32 v4, v4, v77
    v_fma_f32 v82, v82, s38, -v3
    v_mfma_f32_16x16x32_bf16 v[108:111], v[228:231], v[32:35], v[108:111]
    v_exp_f32 v80, v80
    v_add_f32 v4, v4, v78
    v_mfma_f32_16x16x32_bf16 v[112:115], v[160:163], v[36:39], v[112:115]
    v_cvt_pk_bf16_f32 v74, v76, v77
    v_fma_f32 v83, v83, s38, -v3
    v_mfma_f32_16x16x32_bf16 v[116:119], v[164:167], v[36:39], v[116:119]
    v_exp_f32 v81, v81
    v_add_f32 v4, v4, v79
    v_mfma_f32_16x16x32_bf16 v[120:123], v[224:227], v[36:39], v[120:123]
    v_fma_f32 v84, v84, s38, -v3
    v_exp_f32 v82, v82
    v_mfma_f32_16x16x32_bf16 v[124:127], v[228:231], v[36:39], v[124:127]
    ds_read_b128 v[56:59], v15 offset:448
    ds_read_b128 v[60:63], v24 offset:448
    v_mov_b32 v5, v80
    v_cvt_pk_bf16_f32 v75, v78, v79
    ds_write_b128 v25, v[72:75] offset:4288
    s_waitcnt lgkmcnt(6)
    v_mfma_f32_16x16x32_bf16 v[96:99], v[168:171], v[40:43], v[96:99]
    v_fma_f32 v85, v85, s38, -v3
    v_exp_f32 v83, v83
    v_mfma_f32_16x16x32_bf16 v[100:103], v[172:175], v[40:43], v[100:103]
    v_add_f32 v5, v5, v81
    v_fma_f32 v86, v86, s38, -v3
    v_mfma_f32_16x16x32_bf16 v[104:107], v[232:235], v[40:43], v[104:107]
    v_exp_f32 v84, v84
    v_add_f32 v5, v5, v82
    v_mfma_f32_16x16x32_bf16 v[108:111], v[236:239], v[40:43], v[108:111]
    v_cvt_pk_bf16_f32 v80, v80, v81
    v_fma_f32 v87, v87, s38, -v3
    v_mfma_f32_16x16x32_bf16 v[112:115], v[168:171], v[44:47], v[112:115]
    v_exp_f32 v85, v85
    v_add_f32 v5, v5, v83
    v_fma_f32 v88, v88, s38, -v3
    v_mfma_f32_16x16x32_bf16 v[116:119], v[172:175], v[44:47], v[116:119]
    v_exp_f32 v86, v86
    v_mfma_f32_16x16x32_bf16 v[120:123], v[232:235], v[44:47], v[120:123]
    v_add_f32 v5, v5, v84
    v_cvt_pk_bf16_f32 v81, v82, v83
    v_fma_f32 v89, v89, s38, -v3
    v_mfma_f32_16x16x32_bf16 v[124:127], v[236:239], v[44:47], v[124:127]
    s_add_u32 s34, s34, 4224
    s_cmp_eq_u32 s34, 25344
    s_cselect_b32 s34, 0, s34
    v_add_u32 v15, s34, v13
    v_add_u32 v24, s34, v14
    ds_read_b128 v[32:35], v15 offset:0
    ds_read_b128 v[36:39], v24 offset:0
    v_exp_f32 v87, v87
    v_add_f32 v5, v5, v85
    s_waitcnt lgkmcnt(5)
    v_mfma_f32_16x16x32_bf16 v[96:99], v[176:179], v[48:51], v[96:99]
    v_fma_f32 v90, v90, s38, -v3
    v_exp_f32 v88, v88
    v_mfma_f32_16x16x32_bf16 v[100:103], v[180:183], v[48:51], v[100:103]
    v_add_f32 v5, v5, v86
    v_cvt_pk_bf16_f32 v82, v84, v85
    v_mfma_f32_16x16x32_bf16 v[104:107], v[240:243], v[48:51], v[104:107]
    v_fma_f32 v91, v91, s38, -v3
    v_exp_f32 v89, v89
    v_mfma_f32_16x16x32_bf16 v[108:111], v[244:247], v[48:51], v[108:111]
    v_add_f32 v5, v5, v87
    v_fma_f32 v92, v92, s38, -v3
    v_mfma_f32_16x16x32_bf16 v[112:115], v[176:179], v[52:55], v[112:115]
    v_exp_f32 v90, v90
    v_add_f32 v5, v5, v88
    v_cvt_pk_bf16_f32 v83, v86, v87
    v_mfma_f32_16x16x32_bf16 v[116:119], v[180:183], v[52:55], v[116:119]
    ds_write_b128 v26, v[80:83] offset:4224
    v_fma_f32 v93, v93, s38, -v3
    v_mfma_f32_16x16x32_bf16 v[120:123], v[240:243], v[52:55], v[120:123]
    v_exp_f32 v91, v91
    v_add_f32 v5, v5, v89
    v_mfma_f32_16x16x32_bf16 v[124:127], v[244:247], v[52:55], v[124:127]
    ds_read_b128 v[40:43], v15 offset:64
    ds_read_b128 v[44:47], v24 offset:64
    v_fma_f32 v94, v94, s38, -v3
    v_exp_f32 v92, v92
    s_waitcnt lgkmcnt(6)
    v_mfma_f32_16x16x32_bf16 v[96:99], v[184:187], v[56:59], v[96:99]
    v_add_f32 v5, v5, v90
    v_cvt_pk_bf16_f32 v88, v88, v89
    v_fma_f32 v95, v95, s38, -v3
    v_mfma_f32_16x16x32_bf16 v[100:103], v[188:191], v[56:59], v[100:103]
    v_exp_f32 v93, v93
    v_mfma_f32_16x16x32_bf16 v[104:107], v[248:251], v[56:59], v[104:107]
    v_add_f32 v5, v5, v91
    v_exp_f32 v94, v94
    v_mfma_f32_16x16x32_bf16 v[108:111], v[252:255], v[56:59], v[108:111]
    v_add_f32 v5, v5, v92
    v_cvt_pk_bf16_f32 v89, v90, v91
    v_mfma_f32_16x16x32_bf16 v[112:115], v[184:187], v[60:63], v[112:115]
    v_exp_f32 v95, v95
    v_add_f32 v5, v5, v93
    v_add_f32 v5, v5, v94
    v_mfma_f32_16x16x32_bf16 v[116:119], v[188:191], v[60:63], v[116:119]
    v_cvt_pk_bf16_f32 v90, v92, v93
    v_add_f32 v5, v5, v95
    v_mfma_f32_16x16x32_bf16 v[120:123], v[248:251], v[60:63], v[120:123]
    v_cvt_pk_bf16_f32 v91, v94, v95
    ds_write_b128 v26, v[88:91] offset:4288
    s_nop 0
    v_permlane32_swap_b32 v4, v5
    v_mfma_f32_16x16x32_bf16 v[124:127], v[252:255], v[60:63], v[124:127]
    ds_read_b128 v[48:51], v15 offset:128
    ds_read_b128 v[52:55], v24 offset:128
    v_add_f32 v4, v4, v5
    ds_write_b32 v28, v4 offset:768
    s_nop 6
    v_max3_f32 v6, v96, v97, v98
    v_max3_f32 v6, v6, v99, v100
    v_max3_f32 v6, v6, v101, v102
    v_max3_f32 v6, v6, v103, v104
    v_max3_f32 v6, v6, v105, v106
    v_max3_f32 v6, v6, v107, v108
    v_max3_f32 v6, v6, v109, v110
    v_max_f32 v6, v6, v111
    v_max3_f32 v7, v112, v113, v114
    v_max3_f32 v7, v7, v115, v116
    v_max3_f32 v7, v7, v117, v118
    v_max3_f32 v7, v7, v119, v120
    v_max3_f32 v7, v7, v121, v122
    v_max3_f32 v7, v7, v123, v124
    v_max3_f32 v7, v7, v125, v126
    v_max_f32 v7, v7, v127
    s_nop 1
    v_permlane32_swap_b32 v6, v7
    v_max_f32 v6, v6, v7
    ds_write_b32 v28, v6 offset:0
    s_cmp_eq_u32 s33, -1
    s_cbranch_scc1 L_s_w4
    s_waitcnt vmcnt(0)
L_s_w4:
    s_waitcnt vmcnt(4) lgkmcnt(0)
    s_barrier
    s_add_u32 s33, s33, 1
    s_branch L_s_loop0
L_s_last:
    s_waitcnt lgkmcnt(0)
    v_max3_f32 v29, v16, v17, v18
    v_max3_f32 v19, v19, v20, v21
    v_max3_f32 v29, v29, v22, v23
    v_max_f32 v29, v29, v19
    v_mul_f32 v29, s38, v29
    v_mov_b32 v3, v29
    s_nop 1
    v_permlane32_swap_b32 v29, v3
    v_fma_f32 v64, v64, s38, -v29
    v_fma_f32 v65, v65, s38, -v29
    v_fma_f32 v66, v66, s38, -v29
    v_exp_f32 v64, v64
    v_fma_f32 v67, v67, s38, -v29
    v_exp_f32 v65, v65
    v_fma_f32 v68, v68, s38, -v29
    v_exp_f32 v66, v66
    v_mov_b32 v4, v64
    v_fma_f32 v69, v69, s38, -v29
    v_exp_f32 v67, v67
    v_add_f32 v4, v4, v65
    v_fma_f32 v70, v70, s38, -v29
    v_exp_f32 v68, v68
    v_add_f32 v4, v4, v66
    v_cvt_pk_bf16_f32 v64, v64, v65
    v_fma_f32 v71, v71, s38, -v29
    v_exp_f32 v69, v69
    v_add_f32 v4, v4, v67
    v_fma_f32 v72, v72, s38, -v29
    v_exp_f32 v70, v70
    v_add_f32 v4, v4, v68
    v_cvt_pk_bf16_f32 v65, v66, v67
    v_fma_f32 v73, v73, s38, -v29
    v_exp_f32 v71, v71
    v_add_f32 v4, v4, v69
    v_fma_f32 v74, v74, s38, -v29
    v_exp_f32 v72, v72
    v_add_f32 v4, v4, v70
    v_cvt_pk_bf16_f32 v66, v68, v69
    v_fma_f32 v75, v75, s38, -v29
    v_exp_f32 v73, v73
    v_add_f32 v4, v4, v71
    v_fma_f32 v76, v76, s38, -v29
    v_exp_f32 v74, v74
    v_add_f32 v4, v4, v72
    v_cvt_pk_bf16_f32 v67, v70, v71
    ds_write_b128 v25, v[64:67] offset:4224
    v_fma_f32 v77, v77, s38, -v29
    v_exp_f32 v75, v75
    v_add_f32 v4, v4, v73
    v_fma_f32 v78, v78, s38, -v29
    v_exp_f32 v76, v76
    v_add_f32 v4, v4, v74
    v_cvt_pk_bf16_f32 v72, v72, v73
    v_fma_f32 v79, v79, s38, -v29
    v_exp_f32 v77, v77
    v_add_f32 v4, v4, v75
    v_fma_f32 v80, v80, s38, -v3
    v_exp_f32 v78, v78
    v_add_f32 v4, v4, v76
    v_cvt_pk_bf16_f32 v73, v74, v75
    v_fma_f32 v81, v81, s38, -v3
    v_exp_f32 v79, v79
    v_add_f32 v4, v4, v77
    v_fma_f32 v82, v82, s38, -v3
    v_exp_f32 v80, v80
    v_add_f32 v4, v4, v78
    v_cvt_pk_bf16_f32 v74, v76, v77
    v_fma_f32 v83, v83, s38, -v3
    v_exp_f32 v81, v81
    v_add_f32 v4, v4, v79
    v_fma_f32 v84, v84, s38, -v3
    v_exp_f32 v82, v82
    v_mov_b32 v5, v80
    v_cvt_pk_bf16_f32 v75, v78, v79
    ds_write_b128 v25, v[72:75] offset:4288
    v_fma_f32 v85, v85, s38, -v3
    v_exp_f32 v83, v83
    v_add_f32 v5, v5, v81
    v_fma_f32 v86, v86, s38, -v3
    v_exp_f32 v84, v84
    v_add_f32 v5, v5, v82
    v_cvt_pk_bf16_f32 v80, v80, v81
    v_fma_f32 v87, v87, s38, -v3
    v_exp_f32 v85, v85
    v_add_f32 v5, v5, v83
    v_fma_f32 v88, v88, s38, -v3
    v_exp_f32 v86, v86
    v_add_f32 v5, v5, v84
    v_cvt_pk_bf16_f32 v81, v82, v83
    v_fma_f32 v89, v89, s38, -v3
    v_exp_f32 v87, v87
    v_add_f32 v5, v5, v85
    v_fma_f32 v90, v90, s38, -v3
    v_exp_f32 v88, v88
    v_add_f32 v5, v5, v86
    v_cvt_pk_bf16_f32 v82, v84, v85
    v_fma_f32 v91, v91, s38, -v3
    v_exp_f32 v89, v89
    v_add_f32 v5, v5, v87
    v_fma_f32 v92, v92, s38, -v3
    v_exp_f32 v90, v90
    v_add_f32 v5, v5, v88
    v_cvt_pk_bf16_f32 v83, v86, v87
    ds_write_b128 v26, v[80:83] offset:4224
    v_fma_f32 v93, v93, s38, -v3
    v_exp_f32 v91, v91
    v_add_f32 v5, v5, v89
    v_fma_f32 v94, v94, s38, -v3
    v_exp_f32 v92, v92
    v_add_f32 v5, v5, v90
    v_cvt_pk_bf16_f32 v88, v88, v89
    v_fma_f32 v95, v95, s38, -v3
    v_exp_f32 v93, v93
    v_add_f32 v5, v5, v91
    v_exp_f32 v94, v94
    v_add_f32 v5, v5, v92
    v_cvt_pk_bf16_f32 v89, v90, v91
    v_exp_f32 v95, v95
    v_add_f32 v5, v5, v93
    v_add_f32 v5, v5, v94
    v_cvt_pk_bf16_f32 v90, v92, v93
    v_add_f32 v5, v5, v95
    v_cvt_pk_bf16_f32 v91, v94, v95
    ds_write_b128 v26, v[88:91] offset:4288
    s_nop 0
    v_permlane32_swap_b32 v4, v5
    v_add_f32 v4, v4, v5
    ds_write_b32 v28, v4 offset:768
    s_waitcnt lgkmcnt(0)
    s_barrier
    s_endpgm
L_pv:
    s_lshl_b32 s40, s3, 7
    v_add_u32 v12, s40, v12
    s_mov_b32 s51, 0
    v_and_b32 v68, 15, v2
    v_lshrrev_b32 v69, 4, v2
    v_xor_b32 v70, v67, v66
    v_lshlrev_b32 v70, 4, v70
    v_lshl_add_u32 v70, v66, 7, v70
    s_add_u32 s40, s39, 33792
    v_lshlrev_b32 v13, 4, v2
    v_add_u32 v13, s40, v13
    v_bfe_u32 v71, v2, 2, 2
    v_lshl_add_u32 v71, v69, 3, v71
    v_lshlrev_b32 v71, 7, v71
    v_and_b32 v72, 3, v2
    v_lshl_add_u32 v71, v72, 4, v71
    v_add_u32 v14, s40, v71
    v_and_b32 v71, 7, v68
    v_xor_b32 v71, v71, v69
    v_lshlrev_b32 v71, 4, v71
    v_lshl_add_u32 v71, v68, 7, v71
    v_add_u32 v19, s40, v71
    v_xor_b32 v20, 64, v19
    v_add_u32 v18, s40, v70
    v_lshrrev_b32 v71, 3, v68
    v_mul_u32_u24 v15, 40832, v71
    v_bfe_u32 v71, v68, 1, 2
    v_mul_u32_u24 v71, 1056, v71
    v_add_u32 v15, v15, v71
    v_and_b32 v71, 1, v68
    v_lshl_add_u32 v15, v71, 9, v15
    v_xor_b32 v71, v71, v69
    v_lshl_add_u32 v15, v71, 4, v15
    v_add_u32 v15, 25344, v15
    v_add_u32 v16, 81664, v15
    v_lshl_add_u32 v72, v65, 4, v68
    v_lshrrev_b32 v71, 3, v72
    v_mul_u32_u24 v17, 40832, v71
    v_and_b32 v71, 7, v72
    v_lshl_add_u32 v17, v71, 5, v17
    v_add_u32 v17, 38400, v17
    s_barrier
    buffer_load_dwordx4 v[128:131], v12, s[24:27], s51 offen nt
    s_add_u32 s51, s51, 4096
    buffer_load_dwordx4 v[132:135], v12, s[24:27], s51 offen nt
    s_add_u32 s51, s51, 4096
    buffer_load_dwordx4 v[136:139], v12, s[24:27], s51 offen nt
    s_add_u32 s51, s51, 4096
    buffer_load_dwordx4 v[140:143], v12, s[24:27], s51 offen nt
    s_add_u32 s51, s51, 4096
    buffer_load_dwordx4 v[144:147], v12, s[24:27], s51 offen nt
    s_add_u32 s51, s51, 4096
    buffer_load_dwordx4 v[148:151], v12, s[24:27], s51 offen nt
    s_add_u32 s51, s51, 4096
    buffer_load_dwordx4 v[152:155], v12, s[24:27], s51 offen nt
    s_add_u32 s51, s51, 4096
    buffer_load_dwordx4 v[156:159], v12, s[24:27], s51 offen nt
    s_add_u32 s51, s51, 4096
    buffer_load_dwordx4 v[160:163], v12, s[24:27], s51 offen nt
    s_add_u32 s51, s51, 4096
    buffer_load_dwordx4 v[164:167], v12, s[24:27], s51 offen nt
    s_add_u32 s51, s51, 4096
    buffer_load_dwordx4 v[168:171], v12, s[24:27], s51 offen nt
    s_add_u32 s51, s51, 4096
    buffer_load_dwordx4 v[172:175], v12, s[24:27], s51 offen nt
    s_add_u32 s51, s51, 4096
    buffer_load_dwordx4 v[176:179], v12, s[24:27], s51 offen nt
    s_add_u32 s51, s51, 4096
    buffer_load_dwordx4 v[180:183], v12, s[24:27], s51 offen nt
    s_add_u32 s51, s51, 4096
    buffer_load_dwordx4 v[184:187], v12, s[24:27], s51 offen nt
    s_add_u32 s51, s51, 4096
    buffer_load_dwordx4 v[188:191], v12, s[24:27], s51 offen nt
    s_add_u32 s51, s51, 4096
    s_barrier
    s_waitcnt vmcnt(12)
    ds_write_b128 v13, v[128:131] offset:0
    ds_write_b128 v13, v[132:135] offset:1024
    ds_write_b128 v13, v[136:139] offset:2048
    ds_write_b128 v13, v[140:143] offset:3072
    s_waitcnt lgkmcnt(0)
    ds_read_b64_tr_b16 v[128:129], v14 offset:0
    ds_read_b64_tr_b16 v[130:131], v14 offset:512
    ds_read_b64_tr_b16 v[132:133], v14 offset:8
    ds_read_b64_tr_b16 v[134:135], v14 offset:520
    ds_read_b64_tr_b16 v[136:137], v14 offset:64
    ds_read_b64_tr_b16 v[138:139], v14 offset:576
    ds_read_b64_tr_b16 v[140:141], v14 offset:72
    ds_read_b64_tr_b16 v[142:143], v14 offset:584
    buffer_load_dwordx4 v[192:195], v12, s[24:27], s51 offen nt
    s_add_u32 s51, s51, 4096
    buffer_load_dwordx4 v[196:199], v12, s[24:27], s51 offen nt
    s_add_u32 s51, s51, 4096
    buffer_load_dwordx4 v[200:203], v12, s[24:27], s51 offen nt
    s_add_u32 s51, s51, 4096
    buffer_load_dwordx4 v[204:207], v12, s[24:27], s51 offen nt
    s_add_u32 s51, s51, 4096
    s_waitcnt vmcnt(12)
    ds_write_b128 v13, v[144:147] offset:0
    ds_write_b128 v13, v[148:151] offset:1024
    ds_write_b128 v13, v[152:155] offset:2048
    ds_write_b128 v13, v[156:159] offset:3072
    s_waitcnt lgkmcnt(0)
    ds_read_b64_tr_b16 v[144:145], v14 offset:0
    ds_read_b64_tr_b16 v[146:147], v14 offset:512
    ds_read_b64_tr_b16 v[148:149], v14 offset:8
    ds_read_b64_tr_b16 v[150:151], v14 offset:520
    ds_read_b64_tr_b16 v[152:153], v14 offset:64
    ds_read_b64_tr_b16 v[154:155], v14 offset:576
    ds_read_b64_tr_b16 v[156:157], v14 offset:72
    ds_read_b64_tr_b16 v[158:159], v14 offset:584
    buffer_load_dwordx4 v[208:211], v12, s[24:27], s51 offen nt
    s_add_u32 s51, s51, 4096
    buffer_load_dwordx4 v[212:215], v12, s[24:27], s51 offen nt
    s_add_u32 s51, s51, 4096
    buffer_load_dwordx4 v[216:219], v12, s[24:27], s51 offen nt
    s_add_u32 s51, s51, 4096
    buffer_load_dwordx4 v[220:223], v12, s[24:27], s51 offen nt
    s_add_u32 s51, s51, 4096
    s_barrier
    s_waitcnt vmcnt(12)
    ds_write_b128 v13, v[160:163] offset:0
    ds_write_b128 v13, v[164:167] offset:1024
    ds_write_b128 v13, v[168:171] offset:2048
    ds_write_b128 v13, v[172:175] offset:3072
    s_waitcnt lgkmcnt(0)
    ds_read_b64_tr_b16 v[160:161], v14 offset:0
    ds_read_b64_tr_b16 v[162:163], v14 offset:512
    ds_read_b64_tr_b16 v[164:165], v14 offset:8
    ds_read_b64_tr_b16 v[166:167], v14 offset:520
    ds_read_b64_tr_b16 v[168:169], v14 offset:64
    ds_read_b64_tr_b16 v[170:171], v14 offset:576
    ds_read_b64_tr_b16 v[172:173], v14 offset:72
    ds_read_b64_tr_b16 v[174:175], v14 offset:584
    buffer_load_dwordx4 v[224:227], v12, s[24:27], s51 offen nt
    s_add_u32 s51, s51, 4096
    buffer_load_dwordx4 v[228:231], v12, s[24:27], s51 offen nt
    s_add_u32 s51, s51, 4096
    buffer_load_dwordx4 v[232:235], v12, s[24:27], s51 offen nt
    s_add_u32 s51, s51, 4096
    buffer_load_dwordx4 v[236:239], v12, s[24:27], s51 offen nt
    s_add_u32 s51, s51, 4096
    s_waitcnt vmcnt(12)
    ds_write_b128 v13, v[176:179] offset:0
    ds_write_b128 v13, v[180:183] offset:1024
    ds_write_b128 v13, v[184:187] offset:2048
    ds_write_b128 v13, v[188:191] offset:3072
    s_waitcnt lgkmcnt(0)
    ds_read_b64_tr_b16 v[176:177], v14 offset:0
    ds_read_b64_tr_b16 v[178:179], v14 offset:512
    ds_read_b64_tr_b16 v[180:181], v14 offset:8
    ds_read_b64_tr_b16 v[182:183], v14 offset:520
    ds_read_b64_tr_b16 v[184:185], v14 offset:64
    ds_read_b64_tr_b16 v[186:187], v14 offset:576
    ds_read_b64_tr_b16 v[188:189], v14 offset:72
    ds_read_b64_tr_b16 v[190:191], v14 offset:584
    buffer_load_dwordx4 v[240:243], v12, s[24:27], s51 offen nt
    s_add_u32 s51, s51, 4096
    buffer_load_dwordx4 v[244:247], v12, s[24:27], s51 offen nt
    s_add_u32 s51, s51, 4096
    buffer_load_dwordx4 v[248:251], v12, s[24:27], s51 offen nt
    s_add_u32 s51, s51, 4096
    buffer_load_dwordx4 v[252:255], v12, s[24:27], s51 offen nt
    s_add_u32 s51, s51, 4096
    s_barrier
    ds_read_b128 v[32:35], v15 offset:0
    ds_read_b128 v[36:39], v16 offset:0
    ds_read_b128 v[40:43], v15 offset:64
    ds_read_b128 v[44:47], v16 offset:64
    ds_read_b128 v[22:25], v17 offset:0
    ds_read_b128 v[26:29], v17 offset:16
    s_waitcnt lgkmcnt(0)
    v_add_f32 v22, v22, v23
    v_add_f32 v24, v24, v25
    v_add_f32 v26, v26, v27
    v_add_f32 v28, v28, v29
    v_add_f32 v22, v22, v24
    v_add_f32 v26, v26, v28
    v_add_f32 v22, v22, v26
    v_rcp_f32 v4, v22
    s_nop 0
    v_mov_b32 v5, v4
    s_nop 1
    v_permlane32_swap_b32 v4, v5
    s_mov_b32 s54, 65536
    s_add_u32 m0, s39, 16896
    s_nop 0
    buffer_load_dwordx4 v11, s[16:19], s54 offen offset:0 nt lds
    s_add_u32 m0, s39, 16928
    s_nop 0
    buffer_load_dwordx4 v11, s[16:19], s54 offen offset:1024 nt lds
    s_add_u32 m0, s39, 16960
    s_nop 0
    buffer_load_dwordx4 v11, s[16:19], s54 offen offset:2048 nt lds
    s_add_u32 m0, s39, 16992
    s_nop 0
    buffer_load_dwordx4 v11, s[16:19], s54 offen offset:3072 nt lds
    s_waitcnt lgkmcnt(0)
    v_mfma_f32_16x16x32_bf16 v[96:99], v[128:131], v[32:35], 0
    v_mfma_f32_16x16x32_bf16 v[100:103], v[132:135], v[32:35], 0
    v_mfma_f32_16x16x32_bf16 v[104:107], v[136:139], v[32:35], 0
    v_mfma_f32_16x16x32_bf16 v[108:111], v[140:143], v[32:35], 0
    v_mfma_f32_16x16x32_bf16 v[112:115], v[128:131], v[36:39], 0
    v_mfma_f32_16x16x32_bf16 v[116:119], v[132:135], v[36:39], 0
    v_mfma_f32_16x16x32_bf16 v[120:123], v[136:139], v[36:39], 0
    v_mfma_f32_16x16x32_bf16 v[124:127], v[140:143], v[36:39], 0
    s_waitcnt lgkmcnt(0)
    v_mfma_f32_16x16x32_bf16 v[96:99], v[144:147], v[40:43], v[96:99]
    v_mfma_f32_16x16x32_bf16 v[100:103], v[148:151], v[40:43], v[100:103]
    v_mfma_f32_16x16x32_bf16 v[104:107], v[152:155], v[40:43], v[104:107]
    v_mfma_f32_16x16x32_bf16 v[108:111], v[156:159], v[40:43], v[108:111]
    v_mfma_f32_16x16x32_bf16 v[112:115], v[144:147], v[44:47], v[112:115]
    v_mfma_f32_16x16x32_bf16 v[116:119], v[148:151], v[44:47], v[116:119]
    v_mfma_f32_16x16x32_bf16 v[120:123], v[152:155], v[44:47], v[120:123]
    v_mfma_f32_16x16x32_bf16 v[124:127], v[156:159], v[44:47], v[124:127]
    ds_read_b128 v[48:51], v15 offset:128
    ds_read_b128 v[52:55], v16 offset:128
    ds_read_b128 v[56:59], v15 offset:192
    ds_read_b128 v[60:63], v16 offset:192
    s_waitcnt lgkmcnt(0)
    v_mfma_f32_16x16x32_bf16 v[96:99], v[160:163], v[48:51], v[96:99]
    v_mfma_f32_16x16x32_bf16 v[100:103], v[164:167], v[48:51], v[100:103]
    v_mfma_f32_16x16x32_bf16 v[104:107], v[168:171], v[48:51], v[104:107]
    v_mfma_f32_16x16x32_bf16 v[108:111], v[172:175], v[48:51], v[108:111]
    v_mfma_f32_16x16x32_bf16 v[112:115], v[160:163], v[52:55], v[112:115]
    v_mfma_f32_16x16x32_bf16 v[116:119], v[164:167], v[52:55], v[116:119]
    v_mfma_f32_16x16x32_bf16 v[120:123], v[168:171], v[52:55], v[120:123]
    v_mfma_f32_16x16x32_bf16 v[124:127], v[172:175], v[52:55], v[124:127]
    s_waitcnt lgkmcnt(0)
    v_mfma_f32_16x16x32_bf16 v[96:99], v[176:179], v[56:59], v[96:99]
    v_mfma_f32_16x16x32_bf16 v[100:103], v[180:183], v[56:59], v[100:103]
    v_mfma_f32_16x16x32_bf16 v[104:107], v[184:187], v[56:59], v[104:107]
    v_mfma_f32_16x16x32_bf16 v[108:111], v[188:191], v[56:59], v[108:111]
    v_mfma_f32_16x16x32_bf16 v[112:115], v[176:179], v[60:63], v[112:115]
    v_mfma_f32_16x16x32_bf16 v[116:119], v[180:183], v[60:63], v[116:119]
    v_mfma_f32_16x16x32_bf16 v[120:123], v[184:187], v[60:63], v[120:123]
    v_mfma_f32_16x16x32_bf16 v[124:127], v[188:191], v[60:63], v[124:127]
    ds_read_b128 v[32:35], v15 offset:256
    ds_read_b128 v[36:39], v16 offset:256
    s_waitcnt vmcnt(16)
    ds_write_b128 v13, v[192:195] offset:0
    ds_write_b128 v13, v[196:199] offset:1024
    ds_write_b128 v13, v[200:203] offset:2048
    ds_write_b128 v13, v[204:207] offset:3072
    s_waitcnt lgkmcnt(0)
    ds_read_b64_tr_b16 v[192:193], v14 offset:0
    ds_read_b64_tr_b16 v[194:195], v14 offset:512
    ds_read_b64_tr_b16 v[196:197], v14 offset:8
    ds_read_b64_tr_b16 v[198:199], v14 offset:520
    ds_read_b64_tr_b16 v[200:201], v14 offset:64
    ds_read_b64_tr_b16 v[202:203], v14 offset:576
    ds_read_b64_tr_b16 v[204:205], v14 offset:72
    ds_read_b64_tr_b16 v[206:207], v14 offset:584
    s_waitcnt lgkmcnt(0)
    v_mfma_f32_16x16x32_bf16 v[96:99], v[192:195], v[32:35], v[96:99]
    v_mfma_f32_16x16x32_bf16 v[100:103], v[196:199], v[32:35], v[100:103]
    v_mfma_f32_16x16x32_bf16 v[104:107], v[200:203], v[32:35], v[104:107]
    v_mfma_f32_16x16x32_bf16 v[108:111], v[204:207], v[32:35], v[108:111]
    v_mfma_f32_16x16x32_bf16 v[112:115], v[192:195], v[36:39], v[112:115]
    v_mfma_f32_16x16x32_bf16 v[116:119], v[196:199], v[36:39], v[116:119]
    v_mfma_f32_16x16x32_bf16 v[120:123], v[200:203], v[36:39], v[120:123]
    v_mfma_f32_16x16x32_bf16 v[124:127], v[204:207], v[36:39], v[124:127]
    s_mov_b32 s54, 81920
    s_add_u32 m0, s39, 21120
    s_nop 0
    buffer_load_dwordx4 v11, s[16:19], s54 offen offset:0 nt lds
    s_add_u32 m0, s39, 21152
    s_nop 0
    buffer_load_dwordx4 v11, s[16:19], s54 offen offset:1024 nt lds
    s_add_u32 m0, s39, 21184
    s_nop 0
    buffer_load_dwordx4 v11, s[16:19], s54 offen offset:2048 nt lds
    s_add_u32 m0, s39, 21216
    s_nop 0
    buffer_load_dwordx4 v11, s[16:19], s54 offen offset:3072 nt lds
    ds_read_b128 v[40:43], v15 offset:320
    ds_read_b128 v[44:47], v16 offset:320
    s_waitcnt vmcnt(16)
    ds_write_b128 v13, v[208:211] offset:0
    ds_write_b128 v13, v[212:215] offset:1024
    ds_write_b128 v13, v[216:219] offset:2048
    ds_write_b128 v13, v[220:223] offset:3072
    s_waitcnt lgkmcnt(0)
    ds_read_b64_tr_b16 v[208:209], v14 offset:0
    ds_read_b64_tr_b16 v[210:211], v14 offset:512
    ds_read_b64_tr_b16 v[212:213], v14 offset:8
    ds_read_b64_tr_b16 v[214:215], v14 offset:520
    ds_read_b64_tr_b16 v[216:217], v14 offset:64
    ds_read_b64_tr_b16 v[218:219], v14 offset:576
    ds_read_b64_tr_b16 v[220:221], v14 offset:72
    ds_read_b64_tr_b16 v[222:223], v14 offset:584
    s_waitcnt lgkmcnt(0)
    v_mfma_f32_16x16x32_bf16 v[96:99], v[208:211], v[40:43], v[96:99]
    v_mfma_f32_16x16x32_bf16 v[100:103], v[212:215], v[40:43], v[100:103]
    v_mfma_f32_16x16x32_bf16 v[104:107], v[216:219], v[40:43], v[104:107]
    v_mfma_f32_16x16x32_bf16 v[108:111], v[220:223], v[40:43], v[108:111]
    v_mfma_f32_16x16x32_bf16 v[112:115], v[208:211], v[44:47], v[112:115]
    v_mfma_f32_16x16x32_bf16 v[116:119], v[212:215], v[44:47], v[116:119]
    v_mfma_f32_16x16x32_bf16 v[120:123], v[216:219], v[44:47], v[120:123]
    v_mfma_f32_16x16x32_bf16 v[124:127], v[220:223], v[44:47], v[124:127]
    s_mov_b32 s54, 98304
    s_add_u32 m0, s39, 0
    s_nop 0
    buffer_load_dwordx4 v11, s[16:19], s54 offen offset:0 nt lds
    s_add_u32 m0, s39, 32
    s_nop 0
    buffer_load_dwordx4 v11, s[16:19], s54 offen offset:1024 nt lds
    s_add_u32 m0, s39, 64
    s_nop 0
    buffer_load_dwordx4 v11, s[16:19], s54 offen offset:2048 nt lds
    s_add_u32 m0, s39, 96
    s_nop 0
    buffer_load_dwordx4 v11, s[16:19], s54 offen offset:3072 nt lds
    ds_read_b128 v[48:51], v15 offset:384
    ds_read_b128 v[52:55], v16 offset:384
    s_waitcnt vmcnt(16)
    ds_write_b128 v13, v[224:227] offset:0
    ds_write_b128 v13, v[228:231] offset:1024
    ds_write_b128 v13, v[232:235] offset:2048
    ds_write_b128 v13, v[236:239] offset:3072
    s_waitcnt lgkmcnt(0)
    ds_read_b64_tr_b16 v[224:225], v14 offset:0
    ds_read_b64_tr_b16 v[226:227], v14 offset:512
    ds_read_b64_tr_b16 v[228:229], v14 offset:8
    ds_read_b64_tr_b16 v[230:231], v14 offset:520
    ds_read_b64_tr_b16 v[232:233], v14 offset:64
    ds_read_b64_tr_b16 v[234:235], v14 offset:576
    ds_read_b64_tr_b16 v[236:237], v14 offset:72
    ds_read_b64_tr_b16 v[238:239], v14 offset:584
    s_waitcnt lgkmcnt(0)
    v_mfma_f32_16x16x32_bf16 v[96:99], v[224:227], v[48:51], v[96:99]
    v_mfma_f32_16x16x32_bf16 v[100:103], v[228:231], v[48:51], v[100:103]
    v_mfma_f32_16x16x32_bf16 v[104:107], v[232:235], v[48:51], v[104:107]
    v_mfma_f32_16x16x32_bf16 v[108:111], v[236:239], v[48:51], v[108:111]
    v_mfma_f32_16x16x32_bf16 v[112:115], v[224:227], v[52:55], v[112:115]
    v_mfma_f32_16x16x32_bf16 v[116:119], v[228:231], v[52:55], v[116:119]
    v_mfma_f32_16x16x32_bf16 v[120:123], v[232:235], v[52:55], v[120:123]
    v_mfma_f32_16x16x32_bf16 v[124:127], v[236:239], v[52:55], v[124:127]
    s_mov_b32 s54, 114688
    s_add_u32 m0, s39, 4224
    s_nop 0
    buffer_load_dwordx4 v11, s[16:19], s54 offen offset:0 nt lds
    s_add_u32 m0, s39, 4256
    s_nop 0
    buffer_load_dwordx4 v11, s[16:19], s54 offen offset:1024 nt lds
    s_add_u32 m0, s39, 4288
    s_nop 0
    buffer_load_dwordx4 v11, s[16:19], s54 offen offset:2048 nt lds
    s_add_u32 m0, s39, 4320
    s_nop 0
    buffer_load_dwordx4 v11, s[16:19], s54 offen offset:3072 nt lds
    ds_read_b128 v[56:59], v15 offset:448
    ds_read_b128 v[60:63], v16 offset:448
    s_waitcnt vmcnt(16)
    ds_write_b128 v13, v[240:243] offset:0
    ds_write_b128 v13, v[244:247] offset:1024
    ds_write_b128 v13, v[248:251] offset:2048
    ds_write_b128 v13, v[252:255] offset:3072
    s_waitcnt lgkmcnt(0)
    ds_read_b64_tr_b16 v[240:241], v14 offset:0
    ds_read_b64_tr_b16 v[242:243], v14 offset:512
    ds_read_b64_tr_b16 v[244:245], v14 offset:8
    ds_read_b64_tr_b16 v[246:247], v14 offset:520
    ds_read_b64_tr_b16 v[248:249], v14 offset:64
    ds_read_b64_tr_b16 v[250:251], v14 offset:576
    ds_read_b64_tr_b16 v[252:253], v14 offset:72
    ds_read_b64_tr_b16 v[254:255], v14 offset:584
    s_waitcnt lgkmcnt(0)
    s_waitcnt lgkmcnt(0)
    v_mfma_f32_16x16x32_bf16 v[96:99], v[240:243], v[56:59], v[96:99]
    v_mfma_f32_16x16x32_bf16 v[100:103], v[244:247], v[56:59], v[100:103]
    v_mfma_f32_16x16x32_bf16 v[104:107], v[248:251], v[56:59], v[104:107]
    v_mfma_f32_16x16x32_bf16 v[108:111], v[252:255], v[56:59], v[108:111]
    v_mfma_f32_16x16x32_bf16 v[112:115], v[240:243], v[60:63], v[112:115]
    v_mfma_f32_16x16x32_bf16 v[116:119], v[244:247], v[60:63], v[116:119]
    v_mfma_f32_16x16x32_bf16 v[120:123], v[248:251], v[60:63], v[120:123]
    v_mfma_f32_16x16x32_bf16 v[124:127], v[252:255], v[60:63], v[124:127]
    s_barrier
    s_waitcnt lgkmcnt(0)
    s_mov_b32 s33, 2
    s_mov_b32 s48, 131072
    s_add_u32 s50, s39, 8448
    s_mov_b32 s49, 0
    s_add_u32 s41, s39, 25344
    s_branch L_pv_loop1
L_pv_loop0:
    s_cmp_eq_u32 s33, 17
    s_cbranch_scc1 L_pv_last
    ds_read_b128 v[32:35], v15 offset:0
    ds_read_b128 v[36:39], v16 offset:0
    ds_read_b128 v[40:43], v15 offset:64
    ds_read_b128 v[44:47], v16 offset:64
    ds_read_b128 v[48:51], v15 offset:128
    ds_read_b128 v[52:55], v16 offset:128
    ds_read_b128 v[22:25], v17 offset:0
    ds_read_b128 v[26:29], v17 offset:16
    s_waitcnt lgkmcnt(6)
    v_mfma_f32_16x16x32_bf16 v[96:99], v[128:131], v[32:35], 0
    v_mfma_f32_16x16x32_bf16 v[100:103], v[132:135], v[32:35], 0
    v_mfma_f32_16x16x32_bf16 v[104:107], v[136:139], v[32:35], 0
    v_mfma_f32_16x16x32_bf16 v[108:111], v[140:143], v[32:35], 0
    v_mfma_f32_16x16x32_bf16 v[112:115], v[128:131], v[36:39], 0
    v_mfma_f32_16x16x32_bf16 v[116:119], v[132:135], v[36:39], 0
    v_mfma_f32_16x16x32_bf16 v[120:123], v[136:139], v[36:39], 0
    v_mfma_f32_16x16x32_bf16 v[124:127], v[140:143], v[36:39], 0
    ds_read_b128 v[56:59], v15 offset:192
    ds_read_b128 v[60:63], v16 offset:192
    s_waitcnt lgkmcnt(6)
    v_mfma_f32_16x16x32_bf16 v[96:99], v[144:147], v[40:43], v[96:99]
    s_add_u32 m0, s50, 0
    s_nop 0
    buffer_load_dwordx4 v11, s[16:19], s48 offen offset:0 nt lds
    v_mfma_f32_16x16x32_bf16 v[100:103], v[148:151], v[40:43], v[100:103]
    v_mul_f32 v64, v6, v64
    v_mfma_f32_16x16x32_bf16 v[104:107], v[152:155], v[40:43], v[104:107]
    v_mul_f32 v65, v6, v65
    v_mul_f32 v66, v6, v66
    v_mfma_f32_16x16x32_bf16 v[108:111], v[156:159], v[40:43], v[108:111]
    v_mul_f32 v67, v6, v67
    v_mul_f32 v68, v6, v68
    v_mfma_f32_16x16x32_bf16 v[112:115], v[144:147], v[44:47], v[112:115]
    v_mul_f32 v69, v6, v69
    v_mul_f32 v70, v6, v70
    v_mul_f32 v71, v6, v71
    v_mfma_f32_16x16x32_bf16 v[116:119], v[148:151], v[44:47], v[116:119]
    v_cvt_pk_bf16_f32 v64, v64, v65
    v_cvt_pk_bf16_f32 v65, v66, v67
    v_mfma_f32_16x16x32_bf16 v[120:123], v[152:155], v[44:47], v[120:123]
    v_cvt_pk_bf16_f32 v66, v68, v69
    v_cvt_pk_bf16_f32 v67, v70, v71
    s_setprio 1
    v_mfma_f32_16x16x32_bf16 v[124:127], v[156:159], v[44:47], v[124:127]
    ds_read_b128 v[32:35], v15 offset:256
    ds_read_b128 v[36:39], v16 offset:256
    ds_write_b128 v19, v[64:67] offset:0
    v_mul_f32 v72, v6, v72
    v_mul_f32 v73, v6, v73
    s_waitcnt lgkmcnt(7)
    v_mfma_f32_16x16x32_bf16 v[96:99], v[160:163], v[48:51], v[96:99]
    v_mul_f32 v74, v6, v74
    v_mul_f32 v75, v6, v75
    v_mfma_f32_16x16x32_bf16 v[100:103], v[164:167], v[48:51], v[100:103]
    v_mul_f32 v76, v6, v76
    v_mul_f32 v77, v6, v77
    v_mfma_f32_16x16x32_bf16 v[104:107], v[168:171], v[48:51], v[104:107]
    v_mul_f32 v78, v6, v78
    v_mul_f32 v79, v6, v79
    v_mfma_f32_16x16x32_bf16 v[108:111], v[172:175], v[48:51], v[108:111]
    v_cvt_pk_bf16_f32 v72, v72, v73
    v_cvt_pk_bf16_f32 v73, v74, v75
    v_cvt_pk_bf16_f32 v74, v76, v77
    v_mfma_f32_16x16x32_bf16 v[112:115], v[160:163], v[52:55], v[112:115]
    v_cvt_pk_bf16_f32 v75, v78, v79
    ds_write_b128 v20, v[72:75] offset:0
    v_mfma_f32_16x16x32_bf16 v[116:119], v[164:167], v[52:55], v[116:119]
    v_mfma_f32_16x16x32_bf16 v[120:123], v[168:171], v[52:55], v[120:123]
    s_add_u32 m0, s50, 32
    s_nop 0
    buffer_load_dwordx4 v11, s[16:19], s48 offen offset:1024 nt lds
    v_mfma_f32_16x16x32_bf16 v[124:127], v[172:175], v[52:55], v[124:127]
    ds_read_b128 v[40:43], v15 offset:320
    ds_read_b128 v[44:47], v16 offset:320
    v_mul_f32 v80, v7, v80
    s_waitcnt lgkmcnt(6)
    v_mfma_f32_16x16x32_bf16 v[96:99], v[176:179], v[56:59], v[96:99]
    v_mul_f32 v81, v7, v81
    v_mul_f32 v82, v7, v82
    v_mfma_f32_16x16x32_bf16 v[100:103], v[180:183], v[56:59], v[100:103]
    v_mul_f32 v83, v7, v83
    v_mul_f32 v84, v7, v84
    v_mfma_f32_16x16x32_bf16 v[104:107], v[184:187], v[56:59], v[104:107]
    v_mul_f32 v85, v7, v85
    v_mul_f32 v86, v7, v86
    v_mul_f32 v87, v7, v87
    v_mfma_f32_16x16x32_bf16 v[108:111], v[188:191], v[56:59], v[108:111]
    v_cvt_pk_bf16_f32 v80, v80, v81
    v_cvt_pk_bf16_f32 v81, v82, v83
    v_mfma_f32_16x16x32_bf16 v[112:115], v[176:179], v[60:63], v[112:115]
    v_cvt_pk_bf16_f32 v82, v84, v85
    v_cvt_pk_bf16_f32 v83, v86, v87
    v_mfma_f32_16x16x32_bf16 v[116:119], v[180:183], v[60:63], v[116:119]
    ds_write_b128 v19, v[80:83] offset:2048
    v_mul_f32 v88, v7, v88
    v_mul_f32 v89, v7, v89
    v_mfma_f32_16x16x32_bf16 v[120:123], v[184:187], v[60:63], v[120:123]
    v_mul_f32 v90, v7, v90
    v_mul_f32 v91, v7, v91
    s_setprio 0
    v_mfma_f32_16x16x32_bf16 v[124:127], v[188:191], v[60:63], v[124:127]
    ds_read_b128 v[48:51], v15 offset:384
    ds_read_b128 v[52:55], v16 offset:384
    v_mul_f32 v92, v7, v92
    v_mul_f32 v93, v7, v93
    s_waitcnt lgkmcnt(7)
    v_mfma_f32_16x16x32_bf16 v[96:99], v[192:195], v[32:35], v[96:99]
    v_mul_f32 v94, v7, v94
    v_mul_f32 v95, v7, v95
    v_cvt_pk_bf16_f32 v88, v88, v89
    v_mfma_f32_16x16x32_bf16 v[100:103], v[196:199], v[32:35], v[100:103]
    v_cvt_pk_bf16_f32 v89, v90, v91
    v_cvt_pk_bf16_f32 v90, v92, v93
    v_mfma_f32_16x16x32_bf16 v[104:107], v[200:203], v[32:35], v[104:107]
    v_cvt_pk_bf16_f32 v91, v94, v95
    ds_write_b128 v20, v[88:91] offset:2048
    v_mfma_f32_16x16x32_bf16 v[108:111], v[204:207], v[32:35], v[108:111]
    ds_read_b128 v[68:71], v18 offset:0
    ds_read_b128 v[76:79], v18 offset:1024
    v_mfma_f32_16x16x32_bf16 v[112:115], v[192:195], v[36:39], v[112:115]
    ds_read_b128 v[84:87], v18 offset:2048
    ds_read_b128 v[92:95], v18 offset:3072
    v_add_f32 v22, v22, v23
    v_mfma_f32_16x16x32_bf16 v[116:119], v[196:199], v[36:39], v[116:119]
    v_add_f32 v24, v24, v25
    v_add_f32 v26, v26, v27
    v_mfma_f32_16x16x32_bf16 v[120:123], v[200:203], v[36:39], v[120:123]
    v_add_f32 v28, v28, v29
    v_add_f32 v22, v22, v24
    v_mfma_f32_16x16x32_bf16 v[124:127], v[204:207], v[36:39], v[124:127]
    ds_read_b128 v[56:59], v15 offset:448
    ds_read_b128 v[60:63], v16 offset:448
    v_add_f32 v26, v26, v28
    v_add_f32 v22, v22, v26
    s_waitcnt lgkmcnt(10)
    v_mfma_f32_16x16x32_bf16 v[96:99], v[208:211], v[40:43], v[96:99]
    v_rcp_f32 v4, v22
    v_mfma_f32_16x16x32_bf16 v[100:103], v[212:215], v[40:43], v[100:103]
    s_nop 0
    v_mov_b32 v5, v4
    s_nop 1
    v_permlane32_swap_b32 v4, v5
    v_mfma_f32_16x16x32_bf16 v[104:107], v[216:219], v[40:43], v[104:107]
    v_mfma_f32_16x16x32_bf16 v[108:111], v[220:223], v[40:43], v[108:111]
    s_waitcnt lgkmcnt(5)
    buffer_store_dwordx4 v[68:71], v12, s[28:31], s49 offen nt
    s_add_u32 s49, s49, 4096
    v_mfma_f32_16x16x32_bf16 v[112:115], v[208:211], v[44:47], v[112:115]
    v_mfma_f32_16x16x32_bf16 v[116:119], v[212:215], v[44:47], v[116:119]
    v_mfma_f32_16x16x32_bf16 v[120:123], v[216:219], v[44:47], v[120:123]
    s_waitcnt lgkmcnt(4)
    buffer_store_dwordx4 v[76:79], v12, s[28:31], s49 offen nt
    s_add_u32 s49, s49, 4096
    v_mfma_f32_16x16x32_bf16 v[124:127], v[220:223], v[44:47], v[124:127]
    v_mfma_f32_16x16x32_bf16 v[96:99], v[224:227], v[48:51], v[96:99]
    s_add_u32 m0, s50, 64
    s_nop 0
    buffer_load_dwordx4 v11, s[16:19], s48 offen offset:2048 nt lds
    v_mfma_f32_16x16x32_bf16 v[100:103], v[228:231], v[48:51], v[100:103]
    v_mfma_f32_16x16x32_bf16 v[104:107], v[232:235], v[48:51], v[104:107]
    v_mfma_f32_16x16x32_bf16 v[108:111], v[236:239], v[48:51], v[108:111]
    s_waitcnt lgkmcnt(3)
    buffer_store_dwordx4 v[84:87], v12, s[28:31], s49 offen nt
    s_add_u32 s49, s49, 4096
    v_mfma_f32_16x16x32_bf16 v[112:115], v[224:227], v[52:55], v[112:115]
    v_mfma_f32_16x16x32_bf16 v[116:119], v[228:231], v[52:55], v[116:119]
    v_mfma_f32_16x16x32_bf16 v[120:123], v[232:235], v[52:55], v[120:123]
    s_waitcnt lgkmcnt(2)
    buffer_store_dwordx4 v[92:95], v12, s[28:31], s49 offen nt
    s_add_u32 s49, s49, 4096
    v_mfma_f32_16x16x32_bf16 v[124:127], v[236:239], v[52:55], v[124:127]
    s_waitcnt lgkmcnt(0)
    v_mfma_f32_16x16x32_bf16 v[96:99], v[240:243], v[56:59], v[96:99]
    s_add_u32 m0, s50, 96
    s_nop 0
    buffer_load_dwordx4 v11, s[16:19], s48 offen offset:3072 nt lds
    v_mfma_f32_16x16x32_bf16 v[100:103], v[244:247], v[56:59], v[100:103]
    v_mfma_f32_16x16x32_bf16 v[104:107], v[248:251], v[56:59], v[104:107]
    s_add_u32 s48, s48, 16384
    s_add_u32 s50, s50, 4224
    s_cmp_eq_u32 s50, s41
    s_cselect_b32 s50, s39, s50
    v_mfma_f32_16x16x32_bf16 v[108:111], v[252:255], v[56:59], v[108:111]
    v_mfma_f32_16x16x32_bf16 v[112:115], v[240:243], v[60:63], v[112:115]
    v_mfma_f32_16x16x32_bf16 v[116:119], v[244:247], v[60:63], v[116:119]
    v_mfma_f32_16x16x32_bf16 v[120:123], v[248:251], v[60:63], v[120:123]
    v_mfma_f32_16x16x32_bf16 v[124:127], v[252:255], v[60:63], v[124:127]
    s_waitcnt lgkmcnt(0)
    s_cmp_gt_u32 s33, 3
    s_cbranch_scc1 L_wS_0
    s_waitcnt vmcnt(20)
L_wS_0:
    s_waitcnt vmcnt(24)
    s_barrier
    s_add_u32 s33, s33, 1
L_pv_loop1:
    ds_read_b128 v[32:35], v15 offset:4224
    ds_read_b128 v[36:39], v16 offset:4224
    ds_read_b128 v[40:43], v15 offset:4288
    ds_read_b128 v[44:47], v16 offset:4288
    ds_read_b128 v[48:51], v15 offset:4352
    ds_read_b128 v[52:55], v16 offset:4352
    ds_read_b128 v[22:25], v17 offset:256
    ds_read_b128 v[26:29], v17 offset:272
    s_waitcnt lgkmcnt(6)
    v_mfma_f32_16x16x32_bf16 v[64:67], v[128:131], v[32:35], 0
    v_mfma_f32_16x16x32_bf16 v[68:71], v[132:135], v[32:35], 0
    v_mfma_f32_16x16x32_bf16 v[72:75], v[136:139], v[32:35], 0
    v_mfma_f32_16x16x32_bf16 v[76:79], v[140:143], v[32:35], 0
    v_mfma_f32_16x16x32_bf16 v[80:83], v[128:131], v[36:39], 0
    v_mfma_f32_16x16x32_bf16 v[84:87], v[132:135], v[36:39], 0
    v_mfma_f32_16x16x32_bf16 v[88:91], v[136:139], v[36:39], 0
    v_mfma_f32_16x16x32_bf16 v[92:95], v[140:143], v[36:39], 0
    ds_read_b128 v[56:59], v15 offset:4416
    ds_read_b128 v[60:63], v16 offset:4416
    s_waitcnt lgkmcnt(6)
    v_mfma_f32_16x16x32_bf16 v[64:67], v[144:147], v[40:43], v[64:67]
    s_add_u32 m0, s50, 0
    s_nop 0
    buffer_load_dwordx4 v11, s[16:19], s48 offen offset:0 nt lds
    v_mfma_f32_16x16x32_bf16 v[68:71], v[148:151], v[40:43], v[68:71]
    v_mul_f32 v96, v4, v96
    v_mfma_f32_16x16x32_bf16 v[72:75], v[152:155], v[40:43], v[72:75]
    v_mul_f32 v97, v4, v97
    v_mul_f32 v98, v4, v98
    v_mfma_f32_16x16x32_bf16 v[76:79], v[156:159], v[40:43], v[76:79]
    v_mul_f32 v99, v4, v99
    v_mul_f32 v100, v4, v100
    v_mfma_f32_16x16x32_bf16 v[80:83], v[144:147], v[44:47], v[80:83]
    v_mul_f32 v101, v4, v101
    v_mul_f32 v102, v4, v102
    v_mul_f32 v103, v4, v103
    v_mfma_f32_16x16x32_bf16 v[84:87], v[148:151], v[44:47], v[84:87]
    v_cvt_pk_bf16_f32 v96, v96, v97
    v_cvt_pk_bf16_f32 v97, v98, v99
    v_mfma_f32_16x16x32_bf16 v[88:91], v[152:155], v[44:47], v[88:91]
    v_cvt_pk_bf16_f32 v98, v100, v101
    v_cvt_pk_bf16_f32 v99, v102, v103
    s_setprio 1
    v_mfma_f32_16x16x32_bf16 v[92:95], v[156:159], v[44:47], v[92:95]
    ds_read_b128 v[32:35], v15 offset:4480
    ds_read_b128 v[36:39], v16 offset:4480
    ds_write_b128 v19, v[96:99] offset:0
    v_mul_f32 v104, v4, v104
    v_mul_f32 v105, v4, v105
    s_waitcnt lgkmcnt(7)
    v_mfma_f32_16x16x32_bf16 v[64:67], v[160:163], v[48:51], v[64:67]
    v_mul_f32 v106, v4, v106
    v_mul_f32 v107, v4, v107
    v_mfma_f32_16x16x32_bf16 v[68:71], v[164:167], v[48:51], v[68:71]
    v_mul_f32 v108, v4, v108
    v_mul_f32 v109, v4, v109
    v_mfma_f32_16x16x32_bf16 v[72:75], v[168:171], v[48:51], v[72:75]
    v_mul_f32 v110, v4, v110
    v_mul_f32 v111, v4, v111
    v_mfma_f32_16x16x32_bf16 v[76:79], v[172:175], v[48:51], v[76:79]
    v_cvt_pk_bf16_f32 v104, v104, v105
    v_cvt_pk_bf16_f32 v105, v106, v107
    v_cvt_pk_bf16_f32 v106, v108, v109
    v_mfma_f32_16x16x32_bf16 v[80:83], v[160:163], v[52:55], v[80:83]
    v_cvt_pk_bf16_f32 v107, v110, v111
    ds_write_b128 v20, v[104:107] offset:0
    v_mfma_f32_16x16x32_bf16 v[84:87], v[164:167], v[52:55], v[84:87]
    v_mfma_f32_16x16x32_bf16 v[88:91], v[168:171], v[52:55], v[88:91]
    s_add_u32 m0, s50, 32
    s_nop 0
    buffer_load_dwordx4 v11, s[16:19], s48 offen offset:1024 nt lds
    v_mfma_f32_16x16x32_bf16 v[92:95], v[172:175], v[52:55], v[92:95]
    ds_read_b128 v[40:43], v15 offset:4544
    ds_read_b128 v[44:47], v16 offset:4544
    v_mul_f32 v112, v5, v112
    s_waitcnt lgkmcnt(6)
    v_mfma_f32_16x16x32_bf16 v[64:67], v[176:179], v[56:59], v[64:67]
    v_mul_f32 v113, v5, v113
    v_mul_f32 v114, v5, v114
    v_mfma_f32_16x16x32_bf16 v[68:71], v[180:183], v[56:59], v[68:71]
    v_mul_f32 v115, v5, v115
    v_mul_f32 v116, v5, v116
    v_mfma_f32_16x16x32_bf16 v[72:75], v[184:187], v[56:59], v[72:75]
    v_mul_f32 v117, v5, v117
    v_mul_f32 v118, v5, v118
    v_mul_f32 v119, v5, v119
    v_mfma_f32_16x16x32_bf16 v[76:79], v[188:191], v[56:59], v[76:79]
    v_cvt_pk_bf16_f32 v112, v112, v113
    v_cvt_pk_bf16_f32 v113, v114, v115
    v_mfma_f32_16x16x32_bf16 v[80:83], v[176:179], v[60:63], v[80:83]
    v_cvt_pk_bf16_f32 v114, v116, v117
    v_cvt_pk_bf16_f32 v115, v118, v119
    v_mfma_f32_16x16x32_bf16 v[84:87], v[180:183], v[60:63], v[84:87]
    ds_write_b128 v19, v[112:115] offset:2048
    v_mul_f32 v120, v5, v120
    v_mul_f32 v121, v5, v121
    v_mfma_f32_16x16x32_bf16 v[88:91], v[184:187], v[60:63], v[88:91]
    v_mul_f32 v122, v5, v122
    v_mul_f32 v123, v5, v123
    s_setprio 0
    v_mfma_f32_16x16x32_bf16 v[92:95], v[188:191], v[60:63], v[92:95]
    ds_read_b128 v[48:51], v15 offset:4608
    ds_read_b128 v[52:55], v16 offset:4608
    v_mul_f32 v124, v5, v124
    v_mul_f32 v125, v5, v125
    s_waitcnt lgkmcnt(7)
    v_mfma_f32_16x16x32_bf16 v[64:67], v[192:195], v[32:35], v[64:67]
    v_mul_f32 v126, v5, v126
    v_mul_f32 v127, v5, v127
    v_cvt_pk_bf16_f32 v120, v120, v121
    v_mfma_f32_16x16x32_bf16 v[68:71], v[196:199], v[32:35], v[68:71]
    v_cvt_pk_bf16_f32 v121, v122, v123
    v_cvt_pk_bf16_f32 v122, v124, v125
    v_mfma_f32_16x16x32_bf16 v[72:75], v[200:203], v[32:35], v[72:75]
    v_cvt_pk_bf16_f32 v123, v126, v127
    ds_write_b128 v20, v[120:123] offset:2048
    v_mfma_f32_16x16x32_bf16 v[76:79], v[204:207], v[32:35], v[76:79]
    ds_read_b128 v[100:103], v18 offset:0
    ds_read_b128 v[108:111], v18 offset:1024
    v_mfma_f32_16x16x32_bf16 v[80:83], v[192:195], v[36:39], v[80:83]
    ds_read_b128 v[116:119], v18 offset:2048
    ds_read_b128 v[124:127], v18 offset:3072
    v_add_f32 v22, v22, v23
    v_mfma_f32_16x16x32_bf16 v[84:87], v[196:199], v[36:39], v[84:87]
    v_add_f32 v24, v24, v25
    v_add_f32 v26, v26, v27
    v_mfma_f32_16x16x32_bf16 v[88:91], v[200:203], v[36:39], v[88:91]
    v_add_f32 v28, v28, v29
    v_add_f32 v22, v22, v24
    v_mfma_f32_16x16x32_bf16 v[92:95], v[204:207], v[36:39], v[92:95]
    ds_read_b128 v[56:59], v15 offset:4672
    ds_read_b128 v[60:63], v16 offset:4672
    v_add_f32 v26, v26, v28
    v_add_f32 v22, v22, v26
    s_waitcnt lgkmcnt(10)
    v_mfma_f32_16x16x32_bf16 v[64:67], v[208:211], v[40:43], v[64:67]
    v_rcp_f32 v6, v22
    v_mfma_f32_16x16x32_bf16 v[68:71], v[212:215], v[40:43], v[68:71]
    s_nop 0
    v_mov_b32 v7, v6
    s_nop 1
    v_permlane32_swap_b32 v6, v7
    v_mfma_f32_16x16x32_bf16 v[72:75], v[216:219], v[40:43], v[72:75]
    v_mfma_f32_16x16x32_bf16 v[76:79], v[220:223], v[40:43], v[76:79]
    s_waitcnt lgkmcnt(5)
    buffer_store_dwordx4 v[100:103], v12, s[28:31], s49 offen nt
    s_add_u32 s49, s49, 4096
    v_mfma_f32_16x16x32_bf16 v[80:83], v[208:211], v[44:47], v[80:83]
    v_mfma_f32_16x16x32_bf16 v[84:87], v[212:215], v[44:47], v[84:87]
    v_mfma_f32_16x16x32_bf16 v[88:91], v[216:219], v[44:47], v[88:91]
    s_waitcnt lgkmcnt(4)
    buffer_store_dwordx4 v[108:111], v12, s[28:31], s49 offen nt
    s_add_u32 s49, s49, 4096
    v_mfma_f32_16x16x32_bf16 v[92:95], v[220:223], v[44:47], v[92:95]
    v_mfma_f32_16x16x32_bf16 v[64:67], v[224:227], v[48:51], v[64:67]
    s_add_u32 m0, s50, 64
    s_nop 0
    buffer_load_dwordx4 v11, s[16:19], s48 offen offset:2048 nt lds
    v_mfma_f32_16x16x32_bf16 v[68:71], v[228:231], v[48:51], v[68:71]
    v_mfma_f32_16x16x32_bf16 v[72:75], v[232:235], v[48:51], v[72:75]
    v_mfma_f32_16x16x32_bf16 v[76:79], v[236:239], v[48:51], v[76:79]
    s_waitcnt lgkmcnt(3)
    buffer_store_dwordx4 v[116:119], v12, s[28:31], s49 offen nt
    s_add_u32 s49, s49, 4096
    v_mfma_f32_16x16x32_bf16 v[80:83], v[224:227], v[52:55], v[80:83]
    v_mfma_f32_16x16x32_bf16 v[84:87], v[228:231], v[52:55], v[84:87]
    v_mfma_f32_16x16x32_bf16 v[88:91], v[232:235], v[52:55], v[88:91]
    s_waitcnt lgkmcnt(2)
    buffer_store_dwordx4 v[124:127], v12, s[28:31], s49 offen nt
    s_add_u32 s49, s49, 4096
    v_mfma_f32_16x16x32_bf16 v[92:95], v[236:239], v[52:55], v[92:95]
    s_waitcnt lgkmcnt(0)
    v_mfma_f32_16x16x32_bf16 v[64:67], v[240:243], v[56:59], v[64:67]
    s_add_u32 m0, s50, 96
    s_nop 0
    buffer_load_dwordx4 v11, s[16:19], s48 offen offset:3072 nt lds
    v_mfma_f32_16x16x32_bf16 v[68:71], v[244:247], v[56:59], v[68:71]
    v_mfma_f32_16x16x32_bf16 v[72:75], v[248:251], v[56:59], v[72:75]
    s_add_u32 s48, s48, 16384
    s_add_u32 s50, s50, 4224
    s_cmp_eq_u32 s50, s41
    s_cselect_b32 s50, s39, s50
    v_mfma_f32_16x16x32_bf16 v[76:79], v[252:255], v[56:59], v[76:79]
    v_mfma_f32_16x16x32_bf16 v[80:83], v[240:243], v[60:63], v[80:83]
    v_mfma_f32_16x16x32_bf16 v[84:87], v[244:247], v[60:63], v[84:87]
    v_mfma_f32_16x16x32_bf16 v[88:91], v[248:251], v[60:63], v[88:91]
    v_mfma_f32_16x16x32_bf16 v[92:95], v[252:255], v[60:63], v[92:95]
    s_waitcnt lgkmcnt(0)
    s_cmp_eq_u32 s33, 16
    s_cbranch_scc1 L_pv_nb1
    s_cmp_gt_u32 s33, 2
    s_cbranch_scc1 L_wS_1
    s_waitcnt vmcnt(16)
L_wS_1:
    s_waitcnt vmcnt(24)
    s_barrier
L_pv_nb1:
    s_add_u32 s33, s33, 1
    s_branch L_pv_loop0
L_pv_last:
    s_nop 7
    v_mul_f32 v64, v6, v64
    v_mul_f32 v65, v6, v65
    v_mul_f32 v66, v6, v66
    v_mul_f32 v67, v6, v67
    v_mul_f32 v68, v6, v68
    v_mul_f32 v69, v6, v69
    v_mul_f32 v70, v6, v70
    v_mul_f32 v71, v6, v71
    v_cvt_pk_bf16_f32 v64, v64, v65
    v_cvt_pk_bf16_f32 v65, v66, v67
    v_cvt_pk_bf16_f32 v66, v68, v69
    v_cvt_pk_bf16_f32 v67, v70, v71
    ds_write_b128 v19, v[64:67] offset:0
    v_mul_f32 v72, v6, v72
    v_mul_f32 v73, v6, v73
    v_mul_f32 v74, v6, v74
    v_mul_f32 v75, v6, v75
    v_mul_f32 v76, v6, v76
    v_mul_f32 v77, v6, v77
    v_mul_f32 v78, v6, v78
    v_mul_f32 v79, v6, v79
    v_cvt_pk_bf16_f32 v72, v72, v73
    v_cvt_pk_bf16_f32 v73, v74, v75
    v_cvt_pk_bf16_f32 v74, v76, v77
    v_cvt_pk_bf16_f32 v75, v78, v79
    ds_write_b128 v20, v[72:75] offset:0
    v_mul_f32 v80, v7, v80
    v_mul_f32 v81, v7, v81
    v_mul_f32 v82, v7, v82
    v_mul_f32 v83, v7, v83
    v_mul_f32 v84, v7, v84
    v_mul_f32 v85, v7, v85
    v_mul_f32 v86, v7, v86
    v_mul_f32 v87, v7, v87
    v_cvt_pk_bf16_f32 v80, v80, v81
    v_cvt_pk_bf16_f32 v81, v82, v83
    v_cvt_pk_bf16_f32 v82, v84, v85
    v_cvt_pk_bf16_f32 v83, v86, v87
    ds_write_b128 v19, v[80:83] offset:2048
    v_mul_f32 v88, v7, v88
    v_mul_f32 v89, v7, v89
    v_mul_f32 v90, v7, v90
    v_mul_f32 v91, v7, v91
    v_mul_f32 v92, v7, v92
    v_mul_f32 v93, v7, v93
    v_mul_f32 v94, v7, v94
    v_mul_f32 v95, v7, v95
    v_cvt_pk_bf16_f32 v88, v88, v89
    v_cvt_pk_bf16_f32 v89, v90, v91
    v_cvt_pk_bf16_f32 v90, v92, v93
    v_cvt_pk_bf16_f32 v91, v94, v95
    ds_write_b128 v20, v[88:91] offset:2048
    ds_read_b128 v[68:71], v18 offset:0
    ds_read_b128 v[76:79], v18 offset:1024
    ds_read_b128 v[84:87], v18 offset:2048
    ds_read_b128 v[92:95], v18 offset:3072
    s_waitcnt lgkmcnt(3)
    buffer_store_dwordx4 v[68:71], v12, s[28:31], s49 offen nt
    s_add_u32 s49, s49, 4096
    s_waitcnt lgkmcnt(2)
    buffer_store_dwordx4 v[76:79], v12, s[28:31], s49 offen nt
    s_add_u32 s49, s49, 4096
    s_waitcnt lgkmcnt(1)
    buffer_store_dwordx4 v[84:87], v12, s[28:31], s49 offen nt
    s_add_u32 s49, s49, 4096
    s_waitcnt lgkmcnt(0)
    buffer_store_dwordx4 v[92:95], v12, s[28:31], s49 offen nt
    s_add_u32 s49, s49, 4096
L_end:
    s_endpgm
.section .rodata,"a"
.p2align 6
.amdhsa_kernel standalone__gqa_softmax__near_ridge_kernel
  .amdhsa_next_free_vgpr 256
  .amdhsa_next_free_sgpr 96
  .amdhsa_accum_offset 256
  .amdhsa_group_segment_fixed_size 0
  .amdhsa_kernarg_size 48
  .amdhsa_user_sgpr_count 2
  .amdhsa_user_sgpr_kernarg_segment_ptr 1
  .amdhsa_system_sgpr_workgroup_id_x 1
.end_amdhsa_kernel
```
